```python
import torch

def _softmax(x, axis=-1):
    return torch.softmax(x, dim=axis)
def _gelu(x):
    return torch.nn.functional.gelu(x, approximate="tanh")
def _silu(x):
    return torch.nn.functional.silu(x)
def _sigmoid(x):
    return torch.sigmoid(x)
def _layernorm(x, axis=-1, eps=1e-5):
    m = x.mean(dim=axis, keepdim=True)
    v = x.var(dim=axis, keepdim=True, unbiased=False)
    return (x - m) / torch.sqrt(v + eps)
def _scatter_add(tgt, idx, src, axis=0):
    return tgt.clone().index_add_(axis, idx, src)
def _segment_sum(src, seg, n):
    out = torch.zeros((n,) + src.shape[1:], dtype=src.dtype)
    return out.index_add_(0, seg, src)
def _pad(x, pw):
    flat = tuple(v for pair in reversed(pw) for v in pair)
    return torch.nn.functional.pad(x, flat)

kernel_name = 'gated_mix__ssm_conv_h3__mha_block__prompt'

def setup_inputs():

    _w = (lambda a: (lambda t: t.to(torch.bfloat16) if t.is_floating_point() else t)(torch.as_tensor(a)))
    def _A_setup():
        B, S, D = 1, 2048, 448
        ks = 4
        return {
            "q": _w((lambda *s: torch.randn(*s, dtype=torch.bfloat16) * 0.05)(B, S, D)),
            "k": _w((lambda *s: torch.randn(*s, dtype=torch.bfloat16) * 0.4)(B, S, D)),
            "v": _w((lambda *s: torch.randn(*s, dtype=torch.bfloat16) * 0.4)(B, S, D)),
            "shift_k": _w((lambda *s: torch.randn(*s, dtype=torch.bfloat16) * 0.4)(D, ks) * 0.5),
            "ssm_k": _w((lambda *s: torch.randn(*s, dtype=torch.bfloat16) * 0.8)(D, S) * (1.0 / S ** 0.5)),
            "ssm_D": _w((lambda *s: torch.randn(*s, dtype=torch.bfloat16) * 0.4)(D)),
        }
    _A_in = _A_setup()

    def _B_setup():
        B, S, D, H = 1, 2048, 448, 16
        return {
            "x": _w((lambda *s: torch.randn(*s, dtype=torch.bfloat16) * 0.05)(B, S, D)),
            "wqkv": _w((lambda *s: torch.randn(*s, dtype=torch.bfloat16) * 0.8)(D, 3 * D)),
            "wo": _w((lambda *s: torch.randn(*s, dtype=torch.bfloat16) * 0.05)(D, D)),
        }
    _B_in = _B_setup()

    return {
        "A_q": _A_in["q"],
        "A_k": _A_in["k"],
        "A_v": _A_in["v"],
        "A_shift_k": _A_in["shift_k"],
        "A_ssm_k": _A_in["ssm_k"],
        "A_ssm_D": _A_in["ssm_D"],
        "B_x": _B_in["x"],
        "B_wqkv": _B_in["wqkv"],
        "B_wo": _B_in["wo"],
        "gate_w": _w((lambda *s: torch.randn(*s, dtype=torch.bfloat16) * 0.05)(448) * 16.0),
    }

def reference(A_q, A_k, A_v, A_shift_k, A_ssm_k, A_ssm_D, B_x, B_wqkv, B_wo, gate_w):
    def _A_ref(q, k, v, shift_k, ssm_k, ssm_D):
        B, S, D = q.shape
        ks = shift_k.shape[-1]
        k_pad = _pad(k, ((0, 0), (ks - 1, 0), (0, 0)))
        k_shift = torch.zeros_like(k)
        for t in range(ks):
            k_shift = k_shift + k_pad[:, t:t + S, :] * shift_k[:, ks - 1 - t][None, None, :]
        kv = k_shift * v
        L = 2 * S
        kv_pad = _pad(kv, ((0, 0), (0, S), (0, 0)))
        kf_pad = _pad(ssm_k, ((0, 0), (0, S)))
        kv_f = (lambda x, axes=(-2,-1): torch.fft.rfft2(x.float(), dim=axes))(kv_pad[:, None, :, :], axes=(1, 2))
        kf_f = (lambda x, axes=(-2,-1): torch.fft.rfft2(x.float(), dim=axes))(kf_pad[:, None, :], axes=(1, 2))
        kf_f = (lambda x, *d: x.permute(*d))(kf_f, 1, 2, 0)
        y_f = kv_f * kf_f[None, :, :, :]
        y = (lambda x, s, axes=(-2,-1): torch.fft.irfft2(x, s=s, dim=axes).to(torch.bfloat16))(y_f, (1, L), axes=(1, 2))[:, 0, :S, :]
        y = y + kv * ssm_D[None, None, :]
        return q * y

    def _B_ref(x, wqkv, wo):
        B, S, D = x.shape
        H = 16
        Dh = D // H
        qkv = (lambda x, *d: x.permute(*d))((x @ wqkv).reshape(B, S, 3, H, Dh), 2, 0, 3, 1, 4)
        q, k, v = qkv[0], qkv[1], qkv[2]
        scores = torch.einsum("bhqd,bhkd->bhqk", q, k) * (Dh ** -0.5)
        p = _softmax(scores, axis=-1)
        o = torch.einsum("bhqk,bhkd->bhqd", p, v)
        return (lambda x, *d: x.permute(*d))(o, 0, 2, 1, 3).reshape(B, S, D) @ wo

    x = A_q
    g = _sigmoid((x * gate_w).sum(-1, keepdims=True))
    a = _A_ref(x, A_k, A_v, A_shift_k, A_ssm_k, A_ssm_D)
    b = _B_ref(x, B_wqkv, B_wo)
    return g * a + (1 - g) * b
```

```asm
; @launch grid=(256,1,1) block=(512,1,1) lds=160384
.amdgcn_target "amdgcn-amd-amdhsa--gfx950"
.text
.globl gated_mix__ssm_conv_h3__mha_block__prompt_kernel
.p2align 8
.type gated_mix__ssm_conv_h3__mha_block__prompt_kernel,@function
gated_mix__ssm_conv_h3__mha_block__prompt_kernel:
    s_cmp_ge_u32 s2, 256
    s_cbranch_scc1 all_end
    s_load_dwordx2 s[28:29], s[0:1], 96
    s_load_dwordx2 s[4:5], s[0:1], 0
    s_load_dwordx2 s[24:25], s[0:1], 56
    v_lshrrev_b32 v1, 6, v0
    v_and_b32 v0, 63, v0
    s_and_b32 s43, s2, 7
    s_lshr_b32 s44, s2, 3
    v_readfirstlane_b32 s42, v1
    s_and_b32 s45, s44, 7
    s_and_b32 s3, s43, 1
    s_lshl_b32 s40, s3, 3
    s_add_u32 s40, s40, s45
    s_lshr_b32 s3, s43, 1
    s_lshl_b32 s41, s3, 2
    s_lshr_b32 s3, s44, 3
    s_add_u32 s41, s41, s3
    s_cmp_lt_u32 s42, 4
    s_cbranch_scc1 m_start
    s_sub_u32 s42, s42, 4
    v_lshrrev_b32 v1, 3, v0
    v_and_b32 v2, 7, v0
    v_mul_u32_u24 v21, 0xa80, v1
    v_bfe_u32 v22, v0, 4, 1
    v_lshlrev_b32 v22, 2, v22
    v_xor_b32 v22, v2, v22
    v_lshl_add_u32 v128, v22, 4, v21
    v_add_u32 v129, 20480, v128
    v_lshrrev_b32 v20, 4, v0
    v_mul_u32_u24 v21, 0x380, v1
    v_xor_b32 v22, v2, v20
    v_lshlrev_b32 v22, 4, v22
    v_xor_b32 v23, 64, v22
    v_add_u32 v130, v21, v22
    v_add_u32 v131, v21, v23
    v_add_u32 v131, 6144, v131
    v_add_u32 v132, 12288, v130
    v_add_u32 v133, 12288, v131
    s_and_b32 s3, s43, 1
    s_mul_i32 s96, s3, 7
    s_add_u32 s96, s96, s45
    s_add_u32 s96, s96, 7
    s_lshr_b32 s6, s44, 3
    s_lshl_b32 s96, s96, 7
    s_mul_i32 s3, s42, 43008
    s_add_u32 s96, s96, s3
    s_cmp_eq_u32 s45, 7
    s_cselect_b32 s96, 1073741824, s96
    s_lshl_b32 s3, s41, 2
    s_add_u32 s3, s3, s42
    s_mul_i32 s97, s3, 28672
    s_lshl_b32 s98, s42, 11
    s_add_u32 s98, s98, 16384
    s_lshl_b32 s99, s42, 12
    s_lshl_b32 s64, s6, 1
    s_add_u32 s64, s64, s45
    s_mul_i32 s3, s64, 9363
    s_lshr_b32 s3, s3, 16
    s_mul_i32 s3, s3, 7
    s_sub_u32 s64, s64, s3
    s_waitcnt lgkmcnt(0)
    s_mov_b32 s8, s4
    s_mov_b32 s9, s5
    s_mov_b32 s10, 1835008
    s_mov_b32 s11, 0x00020000
    s_mov_b32 s20, s24
    s_mov_b32 s21, s25
    s_mov_b32 s22, 1204224
    s_mov_b32 s23, 0x00020000
    s_mul_i32 s68, s64, 172032
    s_add_u32 s68, s68, s96
    s_lshl_b32 s69, s64, 7
    s_add_u32 s69, s69, s97
    s_add_u32 m0, s98, 0
    s_add_u32 s64, s64, 1
    buffer_load_dwordx4 v128, s[20:23], s68 offen offset:0 lds
    buffer_load_dwordx4 v129, s[20:23], s68 offen offset:1024 lds
    s_add_u32 m0, s99, 0
    s_cmp_eq_u32 s64, 7
    buffer_load_dwordx4 v130, s[8:11], s69 offen offset:0 lds
    buffer_load_dwordx4 v131, s[8:11], s69 offen offset:1024 lds
    buffer_load_dwordx4 v132, s[8:11], s69 offen offset:2048 lds
    buffer_load_dwordx4 v133, s[8:11], s69 offen offset:3072 lds
    s_cselect_b32 s64, 0, s64
    s_mul_i32 s68, s64, 172032
    s_add_u32 s68, s68, s96
    s_lshl_b32 s69, s64, 7
    s_add_u32 s69, s69, s97
    s_add_u32 m0, s98, 24576
    s_add_u32 s64, s64, 1
    buffer_load_dwordx4 v128, s[20:23], s68 offen offset:0 lds
    buffer_load_dwordx4 v129, s[20:23], s68 offen offset:1024 lds
    s_add_u32 m0, s99, 24576
    s_cmp_eq_u32 s64, 7
    buffer_load_dwordx4 v130, s[8:11], s69 offen offset:0 lds
    buffer_load_dwordx4 v131, s[8:11], s69 offen offset:1024 lds
    buffer_load_dwordx4 v132, s[8:11], s69 offen offset:2048 lds
    buffer_load_dwordx4 v133, s[8:11], s69 offen offset:3072 lds
    s_cselect_b32 s64, 0, s64
    s_waitcnt lgkmcnt(0)
    s_add_u32 s28, s28, 0
    s_addc_u32 s29, s29, 0
    s_add_u32 s30, s28, 6225920
    s_addc_u32 s31, s29, 0
    s_load_dword s65, s[30:31], 0
    s_mov_b32 s16, s28
    s_mov_b32 s17, s29
    s_mov_b32 s18, 16777216
    s_mov_b32 s19, 0x00020000
    s_load_dwordx4 s[48:51], s[0:1], 8
    s_load_dwordx4 s[52:55], s[0:1], 24
    s_load_dwordx2 s[56:57], s[0:1], 40
    s_load_dwordx4 s[36:39], s[0:1], 64
    s_load_dwordx2 s[12:13], s[0:1], 80
    s_lshr_b32 s46, s44, 3
    s_lshl_b32 s3, s43, 2
    s_add_u32 s46, s46, s3
    s_mov_b32 s58, 0xffff0000
    s_lshl_b32 s3, s46, 2
    s_add_u32 s3, s3, s42
    s_mul_i32 s3, s3, 14336
    s_lshl_b32 s34, s45, 7
    s_add_u32 s3, s3, s34
    v_lshl_add_u32 v200, v2, 4, v21
    v_add_u32 v200, s3, v200
    v_subrev_u32 v201, 7168, v200
    v_add_u32 v202, 6144, v200
    v_lshrrev_b32 v21, 5, v0
    v_and_b32 v20, 31, v0
    v_lshl_add_u32 v203, v20, 2, s34
    v_lshlrev_b32 v203, 2, v203
    s_mul_i32 s33, s42, 6144
    s_add_u32 s33, s33, 73728
    v_lshlrev_b32 v209, 10, v21
    v_lshl_add_u32 v209, v20, 2, v209
    v_add_u32 v209, s33, v209
    s_lshl_b32 s3, s42, 1
    v_add3_u32 v204, v21, v20, s3
    v_and_b32 v204, 7, v204
    v_lshlrev_b32 v204, 4, v204
    v_lshl_add_u32 v204, v20, 8, v204
    v_add_u32 v204, 135168, v204
    v_lshrrev_b32 v205, 1, v1
    v_add_u32 v205, v205, v2
    v_and_b32 v205, 7, v205
    v_lshlrev_b32 v205, 4, v205
    v_lshl_add_u32 v205, v1, 7, v205
    s_lshl_b32 s3, s42, 11
    s_add_u32 s3, s3, 135168
    v_add_u32 v205, s3, v205
    v_xor_b32 v206, 64, v205
    v_lshlrev_b32 v207, 12, v1
    v_lshl_add_u32 v207, v2, 4, v207
    s_lshl_b32 s34, s34, 11
    s_lshl_b32 s3, s42, 16
    s_add_u32 s34, s34, s3
    s_lshl_b32 s3, s46, 7
    s_add_u32 s34, s34, s3
    s_add_u32 s34, s34, 4194304
    s_cmp_eq_u32 s45, 7
    s_cselect_b32 s35, 1073741824, 0
    s_add_u32 s34, s34, s35
    s_lshl_b32 s59, s2, 2
    s_add_u32 s59, s59, s42
    s_and_b32 s60, s43, 1
    s_lshl_b32 s60, s60, 4
    s_add_u32 s60, s60, s41
    s_mul_i32 s60, s60, 7
    s_add_u32 s60, s60, s45
    s_lshl_b32 s60, s60, 1
    s_lshr_b32 s3, s42, 1
    s_add_u32 s60, s60, s3
    s_lshl_b32 s32, s60, 12
    s_lshl_b32 s61, s43, 3
    s_lshr_b32 s3, s44, 2
    s_add_u32 s61, s61, s3
    s_and_b32 s62, s44, 3
    s_lshl_b32 s62, s62, 2
    s_add_u32 s62, s62, s42
    s_mul_i32 s63, s42, 17152
    s_add_u32 s63, s63, 51328
    v_lshlrev_b32 v1, 4, v0
    v_cmp_gt_u32 vcc, 56, v0
    v_bfrev_b32 v5, -2
    v_lshrrev_b32 v2, 2, v0
    v_cndmask_b32 v208, v5, v1, vcc
    v_and_b32 v3, 3, v0
    v_mul_u32_u24 v213, 0x380, v2
    v_lshl_add_u32 v213, v3, 4, v213
    v_cndmask_b32 v210, v5, v213, vcc
    v_mul_u32_u24 v22, 0xa80, v2
    v_lshlrev_b32 v23, 4, v3
    s_and_b32 s3, s40, 1
    s_lshl_b32 s3, s3, 3
    v_add_u32 v23, s3, v23
    v_cmp_gt_u32 vcc, 56, v23
    v_lshlrev_b32 v27, 12, v2
    s_nop 0
    v_cndmask_b32 v23, 0, v23, vcc
    v_add_u32 v217, v22, v23
    v_lshl_add_u32 v27, v3, 4, v27
    v_lshlrev_b32 v31, 11, v3
    v_bfe_u32 v22, v0, 2, 2
    v_lshlrev_b32 v22, 6, v22
    v_bfe_u32 v23, v0, 4, 1
    v_lshl_add_u32 v22, v23, 5, v22
    v_lshl_add_u32 v22, v3, 3, v22
    v_lshl_add_u32 v29, v21, 8, v22
    v_add_u32 v211, s33, v29
    v_add_u32 v29, s63, v29
    v_mul_u32_u24 v23, 0xc0, v21
    v_add3_u32 v212, v22, v23, s33
    v_lshlrev_b32 v30, 6, v20
    v_lshl_add_u32 v30, v21, 3, v30
    v_add_u32 v30, s63, v30
    v_mul_u32_u24 v4, 0xe00, v21
    v_lshl_add_u32 v4, v20, 1, v4
    v_cmp_gt_u32 vcc, 28, v20
    v_lshlrev_b32 v17, 4, v21
    v_lshlrev_b32 v18, 2, v20
    v_cndmask_b32 v4, v5, v4, vcc
    v_min_u32 v13, 27, v20
    v_lshlrev_b32 v13, 8, v13
    s_bitcmp1_b32 s42, 0
    s_cselect_b32 s3, 1, 0
    s_cselect_b32 s68, 2, 3
    v_mov_b32 v28, s3
    s_mov_b32 exec_lo, 0
    v_mov_b32 v28, s68
    s_mov_b32 exec_lo, -1
    v_lshlrev_b32 v22, 4, v20
    v_lshl_add_u32 v28, v28, 9, v22
    v_and_b32 v20, 15, v0
    v_lshrrev_b32 v21, 4, v0
    v_lshlrev_b32 v22, 3, v21
    v_sub_u32 v22, v20, v22
    v_add_u32 v22, 25, v22
    v_and_b32 v23, 1, v22
    v_sub_u32 v22, v22, v23
    v_mul_u32_u24 v23, 0x1040, v23
    v_lshl_add_u32 v22, v22, 1, v23
    s_add_u32 s3, s63, 4608
    v_add_u32 v8, s3, v22
    v_add_u32 v9, 1024, v8
    v_add_u32 v10, 2048, v8
    v_add_u32 v11, 3072, v8
    v_lshl_add_u32 v22, v20, 1, v21
    s_add_u32 s3, s63, 32
    v_lshl_add_u32 v12, v22, 4, s3
    v_lshlrev_b32 v15, 5, v20
    v_lshl_add_u32 v15, v21, 3, v15
    v_xor_b32 v14, 8, v15
    v_add_u32 v15, s63, v15
    v_add_u32 v14, s63, v14
    v_add_u32 v7, s63, v1
    v_lshl_add_u32 v5, v0, 3, s63
    v_and_b32 v6, 7, v0
    s_lshl_b32 s3, s62, 4
    v_add_u32 v16, s3, v20
    s_lshr_b32 s3, s60, 6
    s_min_u32 s3, s3, 6
    s_lshl_b32 s3, s3, 3
    s_lshl_b32 s68, s42, 6
    s_add_u32 s3, s3, s68
    s_mov_b32 exec_lo, 0x00ff0000
    v_add_u32 v16, s3, v6
    s_mov_b32 exec_lo, 0xff000000
    v_bfe_u32 v22, v0, 1, 1
    v_and_b32 v23, 1, v0
    v_lshl_add_u32 v22, v22, 3, v23
    s_and_b32 s3, s2, 0xc6
    s_lshl_b32 s68, s42, 4
    s_add_u32 s3, s3, s68
    v_add_u32 v16, s3, v22
    s_mov_b32 exec_lo, 0xf0000000
    s_and_b32 s3, s3, 0x3f
    s_bfe_u32 s68, s61, 0x20002
    s_lshl_b32 s68, s68, 6
    s_add_u32 s3, s3, s68
    v_add_u32 v16, s3, v22
    s_mov_b32 exec_lo, -1
    v_lshlrev_b32 v16, 7, v16
    v_lshl_add_u32 v6, v6, 2, s63
    s_lshl_b32 s3, s42, 12
    s_add_u32 s3, s3, 144000
    v_add_u32 v219, s3, v1
    v_mov_b32 v218, v1
    s_bitcmp1_b32 s43, 0
    s_cselect_b32 exec_hi, -1, 0
    s_mov_b32 exec_lo, 0
    v_add_u32 v218, 6656, v1
    s_mov_b64 exec, -1
    v_mov_b32 v196, 0
    v_mov_b32 v197, 0
    v_mov_b32 v198, 0
    v_mov_b32 v199, 0
    v_mov_b32 v19, 0
    v_mov_b32 v25, 143360
    v_mov_b32 v26, 1
    s_lshl_b32 s46, s41, 6
    s_lshl_b32 s3, s40, 2
    s_add_u32 s46, s46, s3
    s_add_u32 s46, s46, s42
    s_mul_i32 s47, s46, 1792
    s_waitcnt lgkmcnt(0)
    s_mul_i32 s65, s65, 0x9e3779b1
    s_add_u32 s65, s65, 0x7f4a7c15
    v_mov_b32 v24, s65
    s_mov_b32 s24, s48
    s_mov_b32 s25, s49
    s_mov_b32 s26, 1835008
    s_mov_b32 s27, 0x00020000
    s_mov_b32 s28, s50
    s_mov_b32 s29, s51
    s_mov_b32 s30, 1835008
    s_mov_b32 s31, 0x00020000
    s_mov_b32 s4, s52
    s_mov_b32 s5, s53
    s_mov_b32 s6, 3584
    s_mov_b32 s7, 0x00020000
    s_mov_b32 s48, s38
    s_mov_b32 s49, s39
    s_mov_b32 s50, 896
    s_mov_b32 s51, 0x00020000
    s_mov_b32 s38, 401408
    s_mov_b32 s39, 0x00020000
    s_mov_b32 s14, 1835008
    s_mov_b32 s15, 0x00020000
    s_lshr_b32 s3, s59, 6
    s_mul_i32 s52, s3, 56
    s_bfe_u32 s3, s59, 0x50001
    s_mul_i32 s3, s3, 12544
    s_add_u32 s52, s52, s3
    s_bitcmp1_b32 s59, 0
    s_cselect_b32 s52, 1073741824, s52
    s_mul_i32 s53, s61, 28672
    s_mul_i32 s3, s62, 56
    s_add_u32 s53, s53, s3
    s_cmp_eq_u32 s45, 7
    s_cselect_b32 s3, 0, s60
    s_lshr_b32 s3, s3, 1
    s_lshl_b32 s3, s3, 2
    s_add_u32 s56, s56, s3
    s_addc_u32 s57, s57, 0
    s_load_dword s89, s[56:57], 0
    s_lshl_b32 s3, s41, 2
    s_add_u32 s3, s3, s42
    s_mul_i32 s90, s3, 57344
    s_movk_i32 s91, 1024
    s_movk_i32 s92, 2048
    s_bitcmp1_b32 s43, 0
    s_cselect_b32 s91, 14336, s91
    s_cselect_b32 s92, 512, s92
    s_cselect_b32 s93, 7, 0
    s_cselect_b32 s94, 28672, 0
    s_cselect_b32 s3, 10, 12
    s_lshl_b32 s3, s45, s3
    s_add_u32 s90, s90, s3
    s_add_u32 s90, s90, s94
    s_add_u32 s93, s93, s45
    s_lshl_b32 s93, s93, 4
    s_add_u32 s93, s93, s41
    s_lshl_b32 s93, s93, 7
    s_add_u32 s93, s93, 6291456
    s_cmp_eq_u32 s45, 7
    s_cselect_b32 s90, 1073741824, s90
    s_cselect_b32 s93, 1073741824, s93
    s_waitcnt vmcnt(6)
    s_barrier
    s_mul_i32 s68, s64, 172032
    s_add_u32 s68, s68, s96
    s_lshl_b32 s69, s64, 7
    s_add_u32 s69, s69, s97
    s_add_u32 m0, s98, 49152
    s_add_u32 s64, s64, 1
    buffer_load_dwordx4 v128, s[20:23], s68 offen offset:0 lds
    buffer_load_dwordx4 v129, s[20:23], s68 offen offset:1024 lds
    s_add_u32 m0, s99, 49152
    s_cmp_eq_u32 s64, 7
    buffer_load_dwordx4 v130, s[8:11], s69 offen offset:0 lds
    buffer_load_dwordx4 v131, s[8:11], s69 offen offset:1024 lds
    buffer_load_dwordx4 v132, s[8:11], s69 offen offset:2048 lds
    buffer_load_dwordx4 v133, s[8:11], s69 offen offset:3072 lds
    s_cselect_b32 s64, 0, s64
    s_waitcnt vmcnt(6)
    s_barrier
    s_mul_i32 s68, s64, 172032
    s_add_u32 s68, s68, s96
    s_lshl_b32 s69, s64, 7
    s_add_u32 s69, s69, s97
    s_add_u32 m0, s98, 73728
    s_add_u32 s64, s64, 1
    buffer_load_dwordx4 v128, s[20:23], s68 offen offset:0 lds
    buffer_load_dwordx4 v129, s[20:23], s68 offen offset:1024 lds
    s_add_u32 m0, s99, 73728
    s_cmp_eq_u32 s64, 7
    buffer_load_dwordx4 v130, s[8:11], s69 offen offset:0 lds
    buffer_load_dwordx4 v131, s[8:11], s69 offen offset:1024 lds
    buffer_load_dwordx4 v132, s[8:11], s69 offen offset:2048 lds
    buffer_load_dwordx4 v133, s[8:11], s69 offen offset:3072 lds
    s_cselect_b32 s64, 0, s64
    s_waitcnt vmcnt(6)
    s_barrier
    s_mul_i32 s68, s64, 172032
    s_add_u32 s68, s68, s96
    s_lshl_b32 s69, s64, 7
    s_add_u32 s69, s69, s97
    s_add_u32 m0, s98, 0
    s_add_u32 s64, s64, 1
    buffer_load_dwordx4 v128, s[20:23], s68 offen offset:0 lds
    buffer_load_dwordx4 v129, s[20:23], s68 offen offset:1024 lds
    s_add_u32 m0, s99, 0
    s_cmp_eq_u32 s64, 7
    buffer_load_dwordx4 v130, s[8:11], s69 offen offset:0 lds
    buffer_load_dwordx4 v131, s[8:11], s69 offen offset:1024 lds
    buffer_load_dwordx4 v132, s[8:11], s69 offen offset:2048 lds
    buffer_load_dwordx4 v133, s[8:11], s69 offen offset:3072 lds
    s_cselect_b32 s64, 0, s64
    s_waitcnt vmcnt(6)
    s_barrier
    s_mul_i32 s68, s64, 172032
    s_add_u32 s68, s68, s96
    s_lshl_b32 s69, s64, 7
    s_add_u32 s69, s69, s97
    s_add_u32 m0, s98, 24576
    s_add_u32 s64, s64, 1
    buffer_load_dwordx4 v128, s[20:23], s68 offen offset:0 lds
    buffer_load_dwordx4 v129, s[20:23], s68 offen offset:1024 lds
    s_add_u32 m0, s99, 24576
    s_cmp_eq_u32 s64, 7
    buffer_load_dwordx4 v130, s[8:11], s69 offen offset:0 lds
    buffer_load_dwordx4 v131, s[8:11], s69 offen offset:1024 lds
    buffer_load_dwordx4 v132, s[8:11], s69 offen offset:2048 lds
    buffer_load_dwordx4 v133, s[8:11], s69 offen offset:3072 lds
    s_cselect_b32 s64, 0, s64
    s_waitcnt vmcnt(6)
    s_barrier
    s_mul_i32 s68, s64, 172032
    s_add_u32 s68, s68, s96
    s_lshl_b32 s69, s64, 7
    s_add_u32 s69, s69, s97
    s_add_u32 m0, s98, 49152
    s_add_u32 s64, s64, 1
    buffer_load_dwordx4 v128, s[20:23], s68 offen offset:0 lds
    buffer_load_dwordx4 v129, s[20:23], s68 offen offset:1024 lds
    s_add_u32 m0, s99, 49152
    s_cmp_eq_u32 s64, 7
    buffer_load_dwordx4 v130, s[8:11], s69 offen offset:0 lds
    buffer_load_dwordx4 v131, s[8:11], s69 offen offset:1024 lds
    buffer_load_dwordx4 v132, s[8:11], s69 offen offset:2048 lds
    buffer_load_dwordx4 v133, s[8:11], s69 offen offset:3072 lds
    s_cselect_b32 s64, 0, s64
    s_mul_i32 s96, s42, 43008
    s_mul_i32 s3, s40, 56
    s_add_u32 s96, s96, s3
    s_lshl_b32 s97, s42, 10
    s_add_u32 s97, s97, 98304
    s_lshl_b32 s98, s59, 9
    s_add_u32 s98, s98, 10485760
    s_bitcmp1_b32 s59, 0
    s_cselect_b32 s98, 1073741824, s98
    s_lshl_b32 s99, s46, 3
    s_add_u32 s99, s99, 6160384
    s_waitcnt vmcnt(6)
    s_barrier
    s_cmp_ge_u32 s44, 7
    s_cbranch_scc1 h_wqnow
    s_waitcnt vmcnt(0)
    s_barrier
    s_mov_b32 s68, 200000
h_swait0:
    ds_read_b32 v22, v25 offset:56
    s_sub_u32 s68, s68, 1
    s_waitcnt lgkmcnt(0)
    v_cmp_gt_u32 vcc, 4, v22
    s_cbranch_scc1 h_swait0_ok
    s_cbranch_vccz h_swait0_ok
    s_sleep 1
    s_branch h_swait0
h_swait0_ok:
    s_mul_i32 s3, s64, 172032
    s_add_u32 s3, s3, s96
    s_add_u32 m0, s97, 0
    s_add_u32 s64, s64, 1
    buffer_load_dwordx4 v217, s[20:23], s3 offen lds
    s_cmp_eq_u32 s64, 7
    s_cselect_b32 s64, 0, s64
    s_mul_i32 s3, s64, 172032
    s_add_u32 s3, s3, s96
    s_add_u32 m0, s97, 4096
    s_add_u32 s64, s64, 1
    buffer_load_dwordx4 v217, s[20:23], s3 offen lds
    s_cmp_eq_u32 s64, 7
    s_cselect_b32 s64, 0, s64
    s_mul_i32 s3, s64, 172032
    s_add_u32 s3, s3, s96
    s_add_u32 m0, s97, 8192
    s_add_u32 s64, s64, 1
    buffer_load_dwordx4 v217, s[20:23], s3 offen lds
    s_cmp_eq_u32 s64, 7
    s_cselect_b32 s64, 0, s64
    s_mul_i32 s3, s64, 172032
    s_add_u32 s3, s3, s96
    s_add_u32 m0, s97, 12288
    s_add_u32 s64, s64, 1
    buffer_load_dwordx4 v217, s[20:23], s3 offen lds
    s_cmp_eq_u32 s64, 7
    s_cselect_b32 s64, 0, s64
    s_mul_i32 s3, s64, 172032
    s_add_u32 s3, s3, s96
    s_add_u32 m0, s97, 16384
    s_add_u32 s64, s64, 1
    buffer_load_dwordx4 v217, s[20:23], s3 offen lds
    s_cmp_eq_u32 s64, 7
    s_cselect_b32 s64, 0, s64
    s_mul_i32 s3, s64, 172032
    s_add_u32 s3, s3, s96
    s_add_u32 m0, s97, 20480
    s_add_u32 s64, s64, 1
    buffer_load_dwordx4 v217, s[20:23], s3 offen lds
    s_cmp_eq_u32 s64, 7
    s_cselect_b32 s64, 0, s64
    s_mul_i32 s3, s64, 172032
    s_add_u32 s3, s3, s96
    s_add_u32 m0, s97, 24576
    s_add_u32 s64, s64, 1
    buffer_load_dwordx4 v217, s[20:23], s3 offen lds
    s_cmp_eq_u32 s64, 7
    s_cselect_b32 s64, 0, s64
    s_branch h_wqout
h_wqnow:
    s_mul_i32 s3, s64, 172032
    s_add_u32 s3, s3, s96
    s_add_u32 m0, s97, 0
    s_add_u32 s64, s64, 1
    buffer_load_dwordx4 v217, s[20:23], s3 offen lds
    s_cmp_eq_u32 s64, 7
    s_cselect_b32 s64, 0, s64
    s_mul_i32 s3, s64, 172032
    s_add_u32 s3, s3, s96
    s_add_u32 m0, s97, 4096
    s_add_u32 s64, s64, 1
    buffer_load_dwordx4 v217, s[20:23], s3 offen lds
    s_cmp_eq_u32 s64, 7
    s_cselect_b32 s64, 0, s64
    s_mul_i32 s3, s64, 172032
    s_add_u32 s3, s3, s96
    s_add_u32 m0, s97, 8192
    s_add_u32 s64, s64, 1
    buffer_load_dwordx4 v217, s[20:23], s3 offen lds
    s_cmp_eq_u32 s64, 7
    s_cselect_b32 s64, 0, s64
    s_mul_i32 s3, s64, 172032
    s_add_u32 s3, s3, s96
    s_add_u32 m0, s97, 12288
    s_add_u32 s64, s64, 1
    buffer_load_dwordx4 v217, s[20:23], s3 offen lds
    s_cmp_eq_u32 s64, 7
    s_cselect_b32 s64, 0, s64
    s_mul_i32 s3, s64, 172032
    s_add_u32 s3, s3, s96
    s_add_u32 m0, s97, 16384
    s_add_u32 s64, s64, 1
    buffer_load_dwordx4 v217, s[20:23], s3 offen lds
    s_cmp_eq_u32 s64, 7
    s_cselect_b32 s64, 0, s64
    s_mul_i32 s3, s64, 172032
    s_add_u32 s3, s3, s96
    s_add_u32 m0, s97, 20480
    s_add_u32 s64, s64, 1
    buffer_load_dwordx4 v217, s[20:23], s3 offen lds
    s_cmp_eq_u32 s64, 7
    s_cselect_b32 s64, 0, s64
    s_mul_i32 s3, s64, 172032
    s_add_u32 s3, s3, s96
    s_add_u32 m0, s97, 24576
    s_add_u32 s64, s64, 1
    buffer_load_dwordx4 v217, s[20:23], s3 offen lds
    s_cmp_eq_u32 s64, 7
    s_cselect_b32 s64, 0, s64
    s_waitcnt vmcnt(7)
    s_barrier
h_wqout:
    s_lshl_b32 s3, s41, 2
    s_add_u32 s3, s3, s42
    s_lshl_b32 s97, s3, 7
    s_add_u32 s97, s97, 6160384
    s_lshl_b32 s96, s3, 15
    s_lshl_b32 s3, s40, 11
    s_add_u32 s96, s96, s3
    s_add_u32 s96, s96, 8388608
    s_cmp_eq_u32 s45, 7
    s_mov_b32 s20, s54
    s_mov_b32 s21, s55
    s_mov_b32 s22, 1835008
    s_cselect_b32 s55, 1073741824, s32
    s_add_u32 s54, s53, 13312
    s_waitcnt vmcnt(3)
    s_mov_b64 exec, 1
    ds_add_u32 v25, v26 offset:16
    s_mov_b64 exec, -1
    s_mov_b32 s68, 200000
h_swait1:
    ds_read_b32 v22, v25 offset:56
    s_sub_u32 s68, s68, 1
    s_waitcnt lgkmcnt(0)
    v_cmp_gt_u32 vcc, 4, v22
    s_cbranch_scc1 h_swait1_ok
    s_cbranch_vccz h_swait1_ok
    s_sleep 1
    s_branch h_swait1
h_swait1_ok:
    ds_read_b128 v[220:223], v219 offset:0
    ds_read_b128 v[224:227], v219 offset:1024
    ds_read_b128 v[228:231], v219 offset:2048
    ds_read_b128 v[232:235], v219 offset:3072
    s_waitcnt lgkmcnt(0)
    s_lshr_b32 s3, s44, 3
    s_bitcmp1_b32 14, s3
    s_cselect_b32 s3, s90, 1073741824
    buffer_store_dwordx4 v[220:223], v218, s[16:19], s3 offen sc1
    s_add_u32 s95, s3, s91
    buffer_store_dwordx4 v[224:227], v218, s[16:19], s95 offen sc1
    s_add_u32 s3, s3, s92
    buffer_store_dwordx4 v[228:231], v218, s[16:19], s3 offen sc1
    s_add_u32 s95, s95, s92
    buffer_store_dwordx4 v[232:235], v218, s[16:19], s95 offen sc1
    s_mov_b32 m0, s33
    s_mov_b32 exec_lo, 0
    s_mov_b32 exec_hi, 0xffffff00
    buffer_load_dwordx4 v201, s[24:27], s35 offen nt lds
    s_mov_b64 exec, -1
    s_add_u32 m0, s33, 1024
    buffer_load_dwordx4 v[60:63], v203, s[4:7], 0 offen
    buffer_load_dwordx4 v200, s[24:27], s35 offen nt lds
    buffer_load_dwordx4 v202, s[24:27], s35 offen offset:1024 nt lds
    s_add_u32 m0, s33, 3072
    s_nop 0
    buffer_load_dwordx4 v200, s[28:31], s35 offen nt lds
    buffer_load_dwordx4 v202, s[28:31], s35 offen offset:1024 nt lds
    s_add_u32 m0, s33, 5120
    buffer_load_dwordx4 v[112:115], v1, s[48:51], 0 offen
    buffer_load_dwordx4 v210, s[36:39], s52 offen nt lds
    buffer_load_dwordx4 v[104:107], v208, s[8:11], s47 offen
    buffer_load_dwordx4 v[108:111], v208, s[8:11], s47 offen offset:896
    s_waitcnt vmcnt(14)
    s_mov_b64 exec, 1
    ds_add_u32 v25, v26 offset:20
    s_mov_b64 exec, -1
    s_lshr_b32 s3, s44, 3
    s_bitcmp1_b32 14, s3
    s_cbranch_scc0 h_pf0
    s_waitcnt vmcnt(10)
    s_mov_b64 exec, 1
    ds_add_rtn_u32 v22, v25, v26 offset:64
    s_waitcnt lgkmcnt(0)
    v_cmp_eq_u32 vcc, 3, v22
    s_and_b64 exec, exec, vcc
    s_cbranch_execz h_pf0
    buffer_store_dword v24, v19, s[16:19], s93 offen sc1
h_pf0:
    s_mov_b64 exec, -1
    s_waitcnt vmcnt(6)
    s_setprio 2
    ds_read_b32 v32, v209 offset:640
    ds_read_b32 v33, v209 offset:768
    ds_read_b32 v34, v209 offset:896
    ds_read_b32 v35, v209 offset:1024
    ds_read_b32 v36, v209 offset:1152
    ds_read_b32 v37, v209 offset:1280
    ds_read_b32 v38, v209 offset:1408
    ds_read_b32 v39, v209 offset:1536
    ds_read_b32 v40, v209 offset:1664
    ds_read_b32 v41, v209 offset:1792
    ds_read_b32 v42, v209 offset:1920
    v_lshlrev_b32 v88, 16, v60
    v_and_b32 v90, s58, v60
    v_lshlrev_b32 v92, 16, v61
    v_and_b32 v94, s58, v61
    v_lshlrev_b32 v89, 16, v62
    v_and_b32 v91, s58, v62
    v_lshlrev_b32 v93, 16, v63
    v_and_b32 v95, s58, v63
    s_waitcnt vmcnt(4) lgkmcnt(0)
    ds_read_b32 v48, v209 offset:3072
    ds_read_b32 v49, v209 offset:3200
    ds_read_b32 v50, v209 offset:3328
    ds_read_b32 v51, v209 offset:3456
    ds_read_b32 v52, v209 offset:3584
    ds_read_b32 v53, v209 offset:3712
    ds_read_b32 v54, v209 offset:3840
    ds_read_b32 v55, v209 offset:3968
    v_lshlrev_b32 v64, 16, v32
    v_and_b32 v65, s58, v32
    v_lshlrev_b32 v66, 16, v33
    v_and_b32 v67, s58, v33
    v_lshlrev_b32 v68, 16, v34
    v_and_b32 v69, s58, v34
    v_lshlrev_b32 v70, 16, v35
    v_and_b32 v71, s58, v35
    v_lshlrev_b32 v72, 16, v36
    v_and_b32 v73, s58, v36
    v_lshlrev_b32 v74, 16, v37
    v_and_b32 v75, s58, v37
    v_lshlrev_b32 v76, 16, v38
    v_and_b32 v77, s58, v38
    v_lshlrev_b32 v78, 16, v39
    v_and_b32 v79, s58, v39
    v_lshlrev_b32 v80, 16, v40
    v_and_b32 v81, s58, v40
    v_lshlrev_b32 v82, 16, v41
    v_and_b32 v83, s58, v41
    v_lshlrev_b32 v84, 16, v42
    v_and_b32 v85, s58, v42
    s_waitcnt lgkmcnt(0)
    v_pk_mul_f32 v[176:177], v[64:65], v[94:95]
    v_lshlrev_b32 v20, 16, v48
    v_pk_fma_f32 v[176:177], v[66:67], v[92:93], v[176:177]
    v_and_b32 v21, s58, v48
    v_pk_fma_f32 v[176:177], v[68:69], v[90:91], v[176:177]
    v_pk_fma_f32 v[176:177], v[70:71], v[88:89], v[176:177]
    v_pk_mul_f32 v[176:177], v[176:177], v[20:21]
    v_pk_mul_f32 v[178:179], v[66:67], v[94:95]
    v_lshlrev_b32 v20, 16, v49
    v_pk_fma_f32 v[178:179], v[68:69], v[92:93], v[178:179]
    v_and_b32 v21, s58, v49
    v_pk_fma_f32 v[178:179], v[70:71], v[90:91], v[178:179]
    v_pk_fma_f32 v[178:179], v[72:73], v[88:89], v[178:179]
    v_pk_mul_f32 v[178:179], v[178:179], v[20:21]
    v_pk_mul_f32 v[180:181], v[68:69], v[94:95]
    v_lshlrev_b32 v20, 16, v50
    v_pk_fma_f32 v[180:181], v[70:71], v[92:93], v[180:181]
    v_and_b32 v21, s58, v50
    v_pk_fma_f32 v[180:181], v[72:73], v[90:91], v[180:181]
    v_pk_fma_f32 v[180:181], v[74:75], v[88:89], v[180:181]
    v_pk_mul_f32 v[180:181], v[180:181], v[20:21]
    v_pk_mul_f32 v[182:183], v[70:71], v[94:95]
    v_lshlrev_b32 v20, 16, v51
    v_pk_fma_f32 v[182:183], v[72:73], v[92:93], v[182:183]
    v_and_b32 v21, s58, v51
    v_pk_fma_f32 v[182:183], v[74:75], v[90:91], v[182:183]
    v_pk_fma_f32 v[182:183], v[76:77], v[88:89], v[182:183]
    v_pk_mul_f32 v[182:183], v[182:183], v[20:21]
    v_pk_mul_f32 v[184:185], v[72:73], v[94:95]
    v_lshlrev_b32 v20, 16, v52
    v_pk_fma_f32 v[184:185], v[74:75], v[92:93], v[184:185]
    v_and_b32 v21, s58, v52
    v_pk_fma_f32 v[184:185], v[76:77], v[90:91], v[184:185]
    v_pk_fma_f32 v[184:185], v[78:79], v[88:89], v[184:185]
    v_pk_mul_f32 v[184:185], v[184:185], v[20:21]
    v_pk_mul_f32 v[186:187], v[74:75], v[94:95]
    v_lshlrev_b32 v20, 16, v53
    v_pk_fma_f32 v[186:187], v[76:77], v[92:93], v[186:187]
    v_and_b32 v21, s58, v53
    v_pk_fma_f32 v[186:187], v[78:79], v[90:91], v[186:187]
    v_pk_fma_f32 v[186:187], v[80:81], v[88:89], v[186:187]
    v_pk_mul_f32 v[186:187], v[186:187], v[20:21]
    v_pk_mul_f32 v[188:189], v[76:77], v[94:95]
    v_lshlrev_b32 v20, 16, v54
    v_pk_fma_f32 v[188:189], v[78:79], v[92:93], v[188:189]
    v_and_b32 v21, s58, v54
    v_pk_fma_f32 v[188:189], v[80:81], v[90:91], v[188:189]
    v_pk_fma_f32 v[188:189], v[82:83], v[88:89], v[188:189]
    v_pk_mul_f32 v[188:189], v[188:189], v[20:21]
    v_pk_mul_f32 v[190:191], v[78:79], v[94:95]
    v_lshlrev_b32 v20, 16, v55
    v_pk_fma_f32 v[190:191], v[80:81], v[92:93], v[190:191]
    v_and_b32 v21, s58, v55
    v_pk_fma_f32 v[190:191], v[82:83], v[90:91], v[190:191]
    v_pk_fma_f32 v[190:191], v[84:85], v[88:89], v[190:191]
    v_pk_mul_f32 v[190:191], v[190:191], v[20:21]
    v_cvt_pk_bf16_f32 v96, v190, v188
    v_cvt_pk_bf16_f32 v97, v186, v184
    v_cvt_pk_bf16_f32 v98, v182, v180
    v_cvt_pk_bf16_f32 v99, v178, v176
    ds_write_b128 v204, v[96:99] offset:0
    v_cvt_pk_bf16_f32 v100, v191, v189
    v_cvt_pk_bf16_f32 v101, v187, v185
    v_cvt_pk_bf16_f32 v102, v183, v181
    v_cvt_pk_bf16_f32 v103, v179, v177
    ds_write_b128 v204, v[100:103] offset:128
    s_waitcnt vmcnt(0)
    ds_read_b64_tr_b16 v[116:117], v211 offset:5120
    ds_read_b64_tr_b16 v[118:119], v212 offset:5632
    v_dot2_f32_bf16 v214, v104, v112, 0
    v_dot2_f32_bf16 v215, v108, v112, 0
    v_dot2_f32_bf16 v214, v105, v113, v214
    v_dot2_f32_bf16 v215, v109, v113, v215
    v_dot2_f32_bf16 v214, v106, v114, v214
    v_dot2_f32_bf16 v215, v110, v114, v215
    v_dot2_f32_bf16 v214, v107, v115, v214
    v_dot2_f32_bf16 v215, v111, v115, v215
    s_add_u32 s33, s34, 32768
    s_waitcnt lgkmcnt(0)
    s_mov_b64 exec, 1
    ds_add_u32 v25, v26 offset:40
    s_mov_b64 exec, -1
    v_and_b32 v119, 0xffff, v119
    s_nop 0
    v_add_f32_dpp v214, v214, v214 row_shr:1
    v_add_f32_dpp v215, v215, v215 row_shr:1
    s_nop 0
    v_add_f32_dpp v214, v214, v214 row_shr:2
    v_add_f32_dpp v215, v215, v215 row_shr:2
    s_nop 0
    v_add_f32_dpp v214, v214, v214 row_shr:4
    v_add_f32_dpp v215, v215, v215 row_shr:4
    s_nop 0
    v_add_f32_dpp v214, v214, v214 row_shr:8
    v_add_f32_dpp v215, v215, v215 row_shr:8
    s_nop 0
    v_add_f32_dpp v214, v214, v214 row_bcast:15 row_mask:0xa
    v_add_f32_dpp v215, v215, v215 row_bcast:15 row_mask:0xa
    s_nop 0
    v_add_f32_dpp v214, v214, v214 row_bcast:31 row_mask:0xc
    v_add_f32_dpp v215, v215, v215 row_bcast:31 row_mask:0xc
    s_nop 0
    v_cvt_pk_bf16_f32 v216, v214, v215
    s_mov_b32 s3, 0xbfb8aa3b
    v_lshlrev_b32 v214, 16, v216
    v_and_b32 v215, s58, v216
    v_mul_f32 v214, s3, v214
    v_mul_f32 v215, s3, v215
    v_exp_f32 v214, v214
    v_exp_f32 v215, v215
    s_nop 0
    v_add_f32 v214, 1.0, v214
    v_add_f32 v215, 1.0, v215
    v_rcp_f32 v214, v214
    v_rcp_f32 v215, v215
    s_add_u32 m0, s63, 4640
    v_cvt_pk_bf16_f32 v216, v214, v215
    v_lshlrev_b32 v214, 16, v216
    v_and_b32 v215, s58, v216
    s_bitcmp1_b32 s60, 0
    s_cselect_b32 s3, 0, 16
    s_lshl_b32 s51, s89, s3
    s_and_b32 s51, s51, s58
    s_mov_b32 s68, 200000
h_twait:
    ds_read_b32 v22, v25 offset:40
    s_sub_u32 s68, s68, 1
    s_waitcnt lgkmcnt(0)
    v_cmp_gt_u32 vcc, 4, v22
    s_cbranch_scc1 h_twait_ok
    s_cbranch_vccz h_twait_ok
    s_sleep 2
    s_branch h_twait
h_twait_ok:
    ds_read_b128 v[136:139], v205
    ds_read_b128 v[140:143], v206 offset:1024
    s_mov_b32 s68, 200000
h_ugate:
    ds_read_b32 v22, v25 offset:48
    s_sub_u32 s68, s68, 1
    s_waitcnt lgkmcnt(0)
    v_cmp_gt_u32 vcc, 4, v22
    s_cbranch_scc1 h_ugate_ok
    s_cbranch_vccz h_ugate_ok
    s_sleep 2
    s_branch h_ugate
h_ugate_ok:
    s_setprio 3
    buffer_store_dwordx4 v[136:139], v207, s[16:19], s34 offen sc1
    buffer_store_dwordx4 v[140:143], v207, s[16:19], s33 offen sc1
    buffer_store_dwordx4 v[116:119], v1, s[16:19], s98 offen sc1
    s_mov_b32 exec_lo, 0
    s_mov_b32 exec_hi, 0x80000000
    buffer_store_dwordx2 v[214:215], v19, s[16:19], s99 offen sc1
    s_mov_b64 exec, -1
    buffer_store_dwordx4 v[196:199], v1, s[16:19], s96 offen sc1
    buffer_store_dwordx4 v[196:199], v1, s[16:19], s96 offen offset:1024 sc1
    buffer_load_dwordx4 v1, s[20:23], s55 offen offset:0 nt lds
    buffer_load_dwordx4 v1, s[20:23], s55 offen offset:1024 nt lds
    buffer_load_dwordx4 v1, s[20:23], s55 offen offset:2048 nt lds
    buffer_load_dwordx4 v1, s[20:23], s55 offen offset:3072 nt lds
    s_add_u32 m0, s63, 13056
    s_nop 0
    buffer_load_dwordx4 v213, s[8:11], s53 offen lds
    buffer_load_dwordx4 v213, s[8:11], s54 offen offset:1024 lds
    ds_write_b64 v5, v[196:197]
    ds_write_b32 v6, v196 offset:4608
    ds_write_b32 v6, v196 offset:8768
    s_lshl_b32 s3, s2, 7
    s_add_u32 s3, s3, 6324224
    s_waitcnt vmcnt(6)
    s_mov_b64 exec, 1
    ds_add_rtn_u32 v22, v25, v26 offset:32
    s_waitcnt lgkmcnt(0)
    v_cmp_eq_u32 vcc, 3, v22
    s_and_b64 exec, exec, vcc
    s_cbranch_execz h_notlast
    buffer_store_dword v24, v19, s[16:19], s3 offen sc1
h_notlast:
    s_mov_b64 exec, -1
    s_lshl_b32 s48, s62, 15
    s_add_u32 s48, s48, 10485760
    s_lshl_b32 s50, s42, 13
    s_add_u32 s49, s48, s50
    s_add_u32 s54, s53, 7168
    s_add_u32 s55, s53, 14336
    s_add_u32 s56, s53, 21504
    s_lshr_b32 s3, s61, 3
    s_lshr_b32 s33, s3, 1
    s_xor_b32 s3, s3, s33
    s_and_b32 s3, s3, 1
    s_lshl_b32 s3, s3, 7
    s_mul_i32 s57, s62, 7168
    s_add_u32 s57, s57, s3
    s_add_u32 s57, s57, 6422528
    s_lshl_b32 s46, s61, 7
    s_add_u32 s46, s46, 6160384
    s_waitcnt vmcnt(0)
    ds_read_b128 v[64:67], v7 offset:4624
    ds_read_b32 v68, v7 offset:4640
    ds_read_b128 v[72:75], v7 offset:5648
    ds_read_b32 v76, v7 offset:5664
    ds_read_b128 v[80:83], v7 offset:6672
    ds_read_b32 v84, v7 offset:6688
    ds_read_b128 v[88:91], v7 offset:7696
    ds_read_b32 v92, v7 offset:7712
    ds_read_b128 v[96:99], v7 offset:7712
    ds_read_b32 v100, v7 offset:7728
    s_waitcnt lgkmcnt(8)
    v_alignbit_b32 v104, v65, v64, 16
    v_alignbit_b32 v105, v66, v65, 16
    v_alignbit_b32 v106, v67, v66, 16
    v_alignbit_b32 v107, v68, v67, 16
    ds_write_b128 v7, v[104:107] offset:8784
    s_waitcnt lgkmcnt(7)
    v_alignbit_b32 v108, v73, v72, 16
    v_alignbit_b32 v109, v74, v73, 16
    v_alignbit_b32 v110, v75, v74, 16
    v_alignbit_b32 v111, v76, v75, 16
    ds_write_b128 v7, v[108:111] offset:9808
    s_waitcnt lgkmcnt(6)
    v_alignbit_b32 v104, v81, v80, 16
    v_alignbit_b32 v105, v82, v81, 16
    v_alignbit_b32 v106, v83, v82, 16
    v_alignbit_b32 v107, v84, v83, 16
    ds_write_b128 v7, v[104:107] offset:10832
    s_waitcnt lgkmcnt(5)
    v_alignbit_b32 v108, v89, v88, 16
    v_alignbit_b32 v109, v90, v89, 16
    v_alignbit_b32 v110, v91, v90, 16
    v_alignbit_b32 v111, v92, v91, 16
    ds_write_b128 v7, v[108:111] offset:11856
    s_waitcnt lgkmcnt(4)
    v_alignbit_b32 v104, v97, v96, 16
    v_alignbit_b32 v105, v98, v97, 16
    v_alignbit_b32 v106, v99, v98, 16
    v_alignbit_b32 v107, v100, v99, 16
    ds_write_b128 v7, v[104:107] offset:11872
    ds_read_b64_tr_b16 v[112:113], v29 offset:13056
    ds_read_b64_tr_b16 v[114:115], v29 offset:13568
    ds_read_b64_tr_b16 v[116:117], v29 offset:14080
    ds_read_b64_tr_b16 v[118:119], v29 offset:14592
    s_mov_b32 s68, 200000
h_sgate:
    ds_read_b32 v22, v25 offset:48
    s_sub_u32 s68, s68, 1
    s_waitcnt lgkmcnt(0)
    v_cmp_gt_u32 vcc, 8, v22
    s_cbranch_scc1 h_sgate_ok
    s_cbranch_vccz h_sgate_ok
    s_sleep 2
    s_branch h_sgate
h_sgate_ok:
    s_mov_b32 s34, 200000
    s_mov_b32 s3, 6324224
    s_mov_b32 exec_hi, 0
h_swait:
    buffer_load_dword v22, v16, s[16:19], s3 offen sc1
    s_sub_u32 s34, s34, 1
    s_waitcnt vmcnt(0)
    v_cmp_ne_u32 vcc, v22, v24
    s_cbranch_scc1 h_sdone
    s_and_b64 exec, exec, vcc
    s_cbranch_execz h_sdone
    s_sleep 6
    s_branch h_swait
h_sdone:
    s_mov_b64 exec, 1
    ds_add_u32 v25, v26 offset:36
    s_mov_b64 exec, -1
    s_mov_b32 s68, 200000
h_lwait:
    ds_read_b32 v22, v25 offset:36
    s_sub_u32 s68, s68, 1
    s_waitcnt lgkmcnt(0)
    v_cmp_gt_u32 vcc, 4, v22
    s_cbranch_scc1 h_lwait_ok
    s_cbranch_vccz h_lwait_ok
    s_sleep 2
    s_branch h_lwait
h_lwait_ok:
    s_add_u32 m0, s63, 512
    s_add_u32 s3, s32, 4194304
    s_add_u32 s3, s3, s35
    buffer_load_dwordx4 v1, s[16:19], s3 offen offset:0 sc1 lds
    buffer_load_dwordx4 v1, s[16:19], s3 offen offset:1024 sc1 lds
    buffer_load_dwordx4 v1, s[16:19], s3 offen offset:2048 sc1 lds
    buffer_load_dwordx4 v1, s[16:19], s3 offen offset:3072 sc1 lds
    buffer_load_dwordx4 v[48:51], v17, s[16:19], s46 offen offset:0 sc1
    buffer_load_dwordx4 v[52:55], v17, s[16:19], s46 offen offset:32 sc1
    buffer_load_dwordx4 v[56:59], v17, s[16:19], s46 offen offset:64 sc1
    buffer_load_dwordx4 v[60:63], v17, s[16:19], s46 offen offset:96 sc1
    buffer_load_dword v21, v18, s[16:19], s97 offen sc1
    s_lshl_b32 s3, s42, 7
    s_add_u32 s3, s3, 143488
    v_add_u32 v20, s3, v18
    s_waitcnt vmcnt(0)
    v_sub_f32 v21, 1.0, v21
    ds_write_b32 v20, v21
    v_lshlrev_b32 v22, 16, v112
    v_and_b32 v23, s58, v112
    v_pk_mul_f32 v[48:49], v[48:49], v[22:23]
    v_lshlrev_b32 v22, 16, v113
    v_and_b32 v23, s58, v113
    v_pk_mul_f32 v[50:51], v[50:51], v[22:23]
    v_lshlrev_b32 v22, 16, v114
    v_and_b32 v23, s58, v114
    v_pk_mul_f32 v[52:53], v[52:53], v[22:23]
    v_lshlrev_b32 v22, 16, v115
    v_and_b32 v23, s58, v115
    v_pk_mul_f32 v[54:55], v[54:55], v[22:23]
    v_lshlrev_b32 v22, 16, v116
    v_and_b32 v23, s58, v116
    v_pk_mul_f32 v[56:57], v[56:57], v[22:23]
    v_lshlrev_b32 v22, 16, v117
    v_and_b32 v23, s58, v117
    v_pk_mul_f32 v[58:59], v[58:59], v[22:23]
    v_lshlrev_b32 v22, 16, v118
    v_and_b32 v23, s58, v118
    v_pk_mul_f32 v[60:61], v[60:61], v[22:23]
    v_lshlrev_b32 v22, 16, v119
    v_and_b32 v23, s58, v119
    v_pk_mul_f32 v[62:63], v[62:63], v[22:23]
    s_waitcnt lgkmcnt(0)
    s_mov_b64 exec, 1
    ds_add_u32 v25, v26 offset:32
    s_mov_b64 exec, -1
    s_waitcnt lgkmcnt(0)
    s_cmp_eq_u32 s45, 7
    s_cbranch_scc1 h_noconv
    s_setprio 0
    s_bitcmp1_b32 s42, 0
    s_cbranch_scc1 h_conv1
    ds_read2_b32 v[72:73], v9 offset0:0 offset1:1
    ds_read2_b32 v[74:75], v9 offset0:2 offset1:3
    ds_read_b128 v[116:119], v12 offset:3008
    ds_read_b128 v[104:107], v12 offset:1472
    ds_read2_b32 v[84:85], v10 offset0:128 offset1:129
    ds_read2_b32 v[86:87], v10 offset0:130 offset1:131
    ds_read_b128 v[100:103], v12 offset:960
    ds_read2_b32 v[88:89], v11 offset0:0 offset1:1
    ds_read2_b32 v[90:91], v11 offset0:2 offset1:3
    ds_read2_b32 v[68:69], v8 offset0:128 offset1:129
    ds_read2_b32 v[70:71], v8 offset0:130 offset1:131
    ds_read2_b32 v[76:77], v9 offset0:128 offset1:129
    ds_read2_b32 v[78:79], v9 offset0:130 offset1:131
    ds_read_b128 v[120:123], v12 offset:3520
    ds_read_b128 v[108:111], v12 offset:1984
    ds_read2_b32 v[80:81], v10 offset0:0 offset1:1
    ds_read2_b32 v[82:83], v10 offset0:2 offset1:3
    ds_read_b128 v[112:115], v12 offset:2496
    ds_read_b128 v[96:99], v12 offset:448
    ds_read2_b32 v[64:65], v8 offset0:0 offset1:1
    ds_read2_b32 v[66:67], v8 offset0:2 offset1:3
    ds_read2_b32 v[92:93], v11 offset0:128 offset1:129
    ds_read2_b32 v[94:95], v11 offset0:130 offset1:131
    ds_read_b128 v[124:127], v12 offset:4032
    s_waitcnt lgkmcnt(15)
    v_mfma_f32_16x16x32_bf16 v[44:47], v[72:75], v[116:119], 0
    ds_read_b128 v[116:119], v12 offset:2944
    v_mfma_f32_16x16x32_bf16 v[40:43], v[72:75], v[104:107], 0
    buffer_load_dwordx4 v[128:131], v1, s[16:19], s49 offen offset:0 sc1
    v_mfma_f32_16x16x32_bf16 v[44:47], v[84:87], v[104:107], v[44:47]
    ds_read2_b32 v[84:85], v10 offset0:144 offset1:145
    ds_read2_b32 v[86:87], v10 offset0:146 offset1:147
    v_mfma_f32_16x16x32_bf16 v[36:39], v[72:75], v[100:103], 0
    ds_read2_b32 v[72:73], v9 offset0:16 offset1:17
    ds_read2_b32 v[74:75], v9 offset0:18 offset1:19
    v_mfma_f32_16x16x32_bf16 v[44:47], v[88:91], v[100:103], v[44:47]
    ds_read2_b32 v[88:89], v11 offset0:16 offset1:17
    ds_read2_b32 v[90:91], v11 offset0:18 offset1:19
    s_waitcnt lgkmcnt(15)
    v_mfma_f32_16x16x32_bf16 v[36:39], v[68:71], v[104:107], v[36:39]
    ds_read_b128 v[104:107], v12 offset:1408
    buffer_load_dwordx4 v[132:135], v1, s[16:19], s49 offen offset:1024 sc1
    v_mfma_f32_16x16x32_bf16 v[40:43], v[76:79], v[100:103], v[40:43]
    ds_read_b128 v[100:103], v12 offset:896
    v_mfma_f32_16x16x32_bf16 v[44:47], v[68:71], v[120:123], v[44:47]
    ds_read_b128 v[120:123], v12 offset:3456
    v_mfma_f32_16x16x32_bf16 v[40:43], v[68:71], v[108:111], v[40:43]
    ds_read2_b32 v[68:69], v8 offset0:144 offset1:145
    ds_read2_b32 v[70:71], v8 offset0:146 offset1:147
    s_waitcnt lgkmcnt(15)
    v_mfma_f32_16x16x32_bf16 v[44:47], v[80:83], v[108:111], v[44:47]
    buffer_load_dwordx4 v[136:139], v1, s[16:19], s49 offen offset:2048 sc1
    v_mfma_f32_16x16x32_bf16 v[44:47], v[76:79], v[112:115], v[44:47]
    v_mfma_f32_16x16x32_bf16 v[36:39], v[76:79], v[96:99], v[36:39]
    ds_read2_b32 v[76:77], v9 offset0:144 offset1:145
    ds_read2_b32 v[78:79], v9 offset0:146 offset1:147
    v_mfma_f32_16x16x32_bf16 v[40:43], v[80:83], v[96:99], v[40:43]
    ds_read2_b32 v[80:81], v10 offset0:16 offset1:17
    ds_read2_b32 v[82:83], v10 offset0:18 offset1:19
    v_mfma_f32_16x16x32_bf16 v[36:39], v[64:67], v[108:111], v[36:39]
    ds_read_b128 v[108:111], v12 offset:1920
    buffer_load_dwordx4 v[140:143], v1, s[16:19], s49 offen offset:3072 sc1
    s_add_u32 s50, s50, 4096
    s_and_b32 s50, s50, 0x7fff
    s_add_u32 s49, s48, s50
    v_mfma_f32_16x16x32_bf16 v[40:43], v[64:67], v[112:115], v[40:43]
    ds_read_b128 v[112:115], v12 offset:2432
    s_waitcnt lgkmcnt(15)
    v_mfma_f32_16x16x32_bf16 v[44:47], v[92:95], v[96:99], v[44:47]
    ds_read2_b32 v[92:93], v11 offset0:144 offset1:145
    ds_read2_b32 v[94:95], v11 offset0:146 offset1:147
    v_mfma_f32_16x16x32_bf16 v[32:35], v[64:67], v[96:99], 0
    ds_read_b128 v[96:99], v12 offset:384
    v_mfma_f32_16x16x32_bf16 v[44:47], v[64:67], v[124:127], v[44:47]
    ds_read2_b32 v[64:65], v8 offset0:16 offset1:17
    ds_read2_b32 v[66:67], v8 offset0:18 offset1:19
    ds_read_b128 v[124:127], v12 offset:3968
    s_waitcnt lgkmcnt(15)
    v_mfma_f32_16x16x32_bf16 v[44:47], v[72:75], v[116:119], v[44:47]
    ds_read_b128 v[116:119], v12 offset:2880
    v_mfma_f32_16x16x32_bf16 v[40:43], v[72:75], v[104:107], v[40:43]
    buffer_load_dwordx4 v[144:147], v1, s[16:19], s49 offen offset:0 sc1
    v_mfma_f32_16x16x32_bf16 v[44:47], v[84:87], v[104:107], v[44:47]
    ds_read2_b32 v[84:85], v10 offset0:160 offset1:161
    ds_read2_b32 v[86:87], v10 offset0:162 offset1:163
    v_mfma_f32_16x16x32_bf16 v[36:39], v[72:75], v[100:103], v[36:39]
    ds_read2_b32 v[72:73], v9 offset0:32 offset1:33
    ds_read2_b32 v[74:75], v9 offset0:34 offset1:35
    v_mfma_f32_16x16x32_bf16 v[44:47], v[88:91], v[100:103], v[44:47]
    ds_read2_b32 v[88:89], v11 offset0:32 offset1:33
    ds_read2_b32 v[90:91], v11 offset0:34 offset1:35
    s_waitcnt lgkmcnt(15)
    v_mfma_f32_16x16x32_bf16 v[36:39], v[68:71], v[104:107], v[36:39]
    ds_read_b128 v[104:107], v12 offset:1344
    buffer_load_dwordx4 v[148:151], v1, s[16:19], s49 offen offset:1024 sc1
    v_mfma_f32_16x16x32_bf16 v[40:43], v[76:79], v[100:103], v[40:43]
    ds_read_b128 v[100:103], v12 offset:832
    v_mfma_f32_16x16x32_bf16 v[44:47], v[68:71], v[120:123], v[44:47]
    ds_read_b128 v[120:123], v12 offset:3392
    s_waitcnt lgkmcnt(15)
    v_mfma_f32_16x16x32_bf16 v[40:43], v[68:71], v[108:111], v[40:43]
    ds_read2_b32 v[68:69], v8 offset0:160 offset1:161
    ds_read2_b32 v[70:71], v8 offset0:162 offset1:163
    v_mfma_f32_16x16x32_bf16 v[44:47], v[80:83], v[108:111], v[44:47]
    buffer_load_dwordx4 v[152:155], v1, s[16:19], s49 offen offset:2048 sc1
    v_mfma_f32_16x16x32_bf16 v[44:47], v[76:79], v[112:115], v[44:47]
    s_waitcnt lgkmcnt(15)
    v_mfma_f32_16x16x32_bf16 v[36:39], v[76:79], v[96:99], v[36:39]
    ds_read2_b32 v[76:77], v9 offset0:160 offset1:161
    ds_read2_b32 v[78:79], v9 offset0:162 offset1:163
    v_mfma_f32_16x16x32_bf16 v[40:43], v[80:83], v[96:99], v[40:43]
    ds_read2_b32 v[80:81], v10 offset0:32 offset1:33
    ds_read2_b32 v[82:83], v10 offset0:34 offset1:35
    s_waitcnt lgkmcnt(15)
    v_mfma_f32_16x16x32_bf16 v[36:39], v[64:67], v[108:111], v[36:39]
    ds_read_b128 v[108:111], v12 offset:1856
    buffer_load_dwordx4 v[156:159], v1, s[16:19], s49 offen offset:3072 sc1
    s_add_u32 s50, s50, 4096
    s_and_b32 s50, s50, 0x7fff
    s_add_u32 s49, s48, s50
    v_mfma_f32_16x16x32_bf16 v[40:43], v[64:67], v[112:115], v[40:43]
    ds_read_b128 v[112:115], v12 offset:2368
    v_mfma_f32_16x16x32_bf16 v[44:47], v[92:95], v[96:99], v[44:47]
    ds_read2_b32 v[92:93], v11 offset0:160 offset1:161
    ds_read2_b32 v[94:95], v11 offset0:162 offset1:163
    v_mfma_f32_16x16x32_bf16 v[32:35], v[64:67], v[96:99], v[32:35]
    ds_read_b128 v[96:99], v12 offset:320
    v_mfma_f32_16x16x32_bf16 v[44:47], v[64:67], v[124:127], v[44:47]
    ds_read2_b32 v[64:65], v8 offset0:32 offset1:33
    ds_read2_b32 v[66:67], v8 offset0:34 offset1:35
    ds_read_b128 v[124:127], v12 offset:3904
    s_waitcnt lgkmcnt(15)
    v_mfma_f32_16x16x32_bf16 v[44:47], v[72:75], v[116:119], v[44:47]
    ds_read_b128 v[116:119], v12 offset:2816
    v_mfma_f32_16x16x32_bf16 v[40:43], v[72:75], v[104:107], v[40:43]
    buffer_load_dwordx4 v[160:163], v1, s[16:19], s49 offen offset:0 sc1
    v_mfma_f32_16x16x32_bf16 v[44:47], v[84:87], v[104:107], v[44:47]
    ds_read2_b32 v[84:85], v10 offset0:176 offset1:177
    ds_read2_b32 v[86:87], v10 offset0:178 offset1:179
    v_mfma_f32_16x16x32_bf16 v[36:39], v[72:75], v[100:103], v[36:39]
    ds_read2_b32 v[72:73], v9 offset0:48 offset1:49
    ds_read2_b32 v[74:75], v9 offset0:50 offset1:51
    v_mfma_f32_16x16x32_bf16 v[44:47], v[88:91], v[100:103], v[44:47]
    ds_read2_b32 v[88:89], v11 offset0:48 offset1:49
    ds_read2_b32 v[90:91], v11 offset0:50 offset1:51
    s_waitcnt lgkmcnt(15)
    v_mfma_f32_16x16x32_bf16 v[36:39], v[68:71], v[104:107], v[36:39]
    ds_read_b128 v[104:107], v12 offset:1280
    buffer_load_dwordx4 v[164:167], v1, s[16:19], s49 offen offset:1024 sc1
    v_mfma_f32_16x16x32_bf16 v[40:43], v[76:79], v[100:103], v[40:43]
    ds_read_b128 v[100:103], v12 offset:768
    v_mfma_f32_16x16x32_bf16 v[44:47], v[68:71], v[120:123], v[44:47]
    ds_read_b128 v[120:123], v12 offset:3328
    s_waitcnt lgkmcnt(15)
    v_mfma_f32_16x16x32_bf16 v[40:43], v[68:71], v[108:111], v[40:43]
    ds_read2_b32 v[68:69], v8 offset0:176 offset1:177
    ds_read2_b32 v[70:71], v8 offset0:178 offset1:179
    v_mfma_f32_16x16x32_bf16 v[44:47], v[80:83], v[108:111], v[44:47]
    buffer_load_dwordx4 v[168:171], v1, s[16:19], s49 offen offset:2048 sc1
    v_mfma_f32_16x16x32_bf16 v[44:47], v[76:79], v[112:115], v[44:47]
    s_waitcnt lgkmcnt(15)
    v_mfma_f32_16x16x32_bf16 v[36:39], v[76:79], v[96:99], v[36:39]
    ds_read2_b32 v[76:77], v9 offset0:176 offset1:177
    ds_read2_b32 v[78:79], v9 offset0:178 offset1:179
    v_mfma_f32_16x16x32_bf16 v[40:43], v[80:83], v[96:99], v[40:43]
    ds_read2_b32 v[80:81], v10 offset0:48 offset1:49
    ds_read2_b32 v[82:83], v10 offset0:50 offset1:51
    s_waitcnt lgkmcnt(15)
    v_mfma_f32_16x16x32_bf16 v[36:39], v[64:67], v[108:111], v[36:39]
    ds_read_b128 v[108:111], v12 offset:1792
    buffer_load_dwordx4 v[172:175], v1, s[16:19], s49 offen offset:3072 sc1
    s_add_u32 s50, s50, 4096
    s_and_b32 s50, s50, 0x7fff
    s_add_u32 s49, s48, s50
    v_mfma_f32_16x16x32_bf16 v[40:43], v[64:67], v[112:115], v[40:43]
    ds_read_b128 v[112:115], v12 offset:2304
    v_mfma_f32_16x16x32_bf16 v[44:47], v[92:95], v[96:99], v[44:47]
    ds_read2_b32 v[92:93], v11 offset0:176 offset1:177
    ds_read2_b32 v[94:95], v11 offset0:178 offset1:179
    v_mfma_f32_16x16x32_bf16 v[32:35], v[64:67], v[96:99], v[32:35]
    ds_read_b128 v[96:99], v12 offset:256
    v_mfma_f32_16x16x32_bf16 v[44:47], v[64:67], v[124:127], v[44:47]
    ds_read2_b32 v[64:65], v8 offset0:48 offset1:49
    ds_read2_b32 v[66:67], v8 offset0:50 offset1:51
    ds_read_b128 v[124:127], v12 offset:3840
    s_waitcnt lgkmcnt(15)
    v_mfma_f32_16x16x32_bf16 v[44:47], v[72:75], v[116:119], v[44:47]
    ds_read_b128 v[116:119], v12 offset:2752
    v_mfma_f32_16x16x32_bf16 v[40:43], v[72:75], v[104:107], v[40:43]
    buffer_load_dwordx4 v[176:179], v1, s[16:19], s49 offen offset:0 sc1
    v_mfma_f32_16x16x32_bf16 v[44:47], v[84:87], v[104:107], v[44:47]
    ds_read2_b32 v[84:85], v10 offset0:192 offset1:193
    ds_read2_b32 v[86:87], v10 offset0:194 offset1:195
    v_mfma_f32_16x16x32_bf16 v[36:39], v[72:75], v[100:103], v[36:39]
    ds_read2_b32 v[72:73], v9 offset0:64 offset1:65
    ds_read2_b32 v[74:75], v9 offset0:66 offset1:67
    v_mfma_f32_16x16x32_bf16 v[44:47], v[88:91], v[100:103], v[44:47]
    ds_read2_b32 v[88:89], v11 offset0:64 offset1:65
    ds_read2_b32 v[90:91], v11 offset0:66 offset1:67
    s_waitcnt lgkmcnt(15)
    v_mfma_f32_16x16x32_bf16 v[36:39], v[68:71], v[104:107], v[36:39]
    ds_read_b128 v[104:107], v12 offset:1216
    buffer_load_dwordx4 v[180:183], v1, s[16:19], s49 offen offset:1024 sc1
    v_mfma_f32_16x16x32_bf16 v[40:43], v[76:79], v[100:103], v[40:43]
    ds_read_b128 v[100:103], v12 offset:704
    v_mfma_f32_16x16x32_bf16 v[44:47], v[68:71], v[120:123], v[44:47]
    ds_read_b128 v[120:123], v12 offset:3264
    s_waitcnt lgkmcnt(15)
    v_mfma_f32_16x16x32_bf16 v[40:43], v[68:71], v[108:111], v[40:43]
    ds_read2_b32 v[68:69], v8 offset0:192 offset1:193
    ds_read2_b32 v[70:71], v8 offset0:194 offset1:195
    v_mfma_f32_16x16x32_bf16 v[44:47], v[80:83], v[108:111], v[44:47]
    buffer_load_dwordx4 v[184:187], v1, s[16:19], s49 offen offset:2048 sc1
    v_mfma_f32_16x16x32_bf16 v[44:47], v[76:79], v[112:115], v[44:47]
    s_waitcnt lgkmcnt(15)
    v_mfma_f32_16x16x32_bf16 v[36:39], v[76:79], v[96:99], v[36:39]
    ds_read2_b32 v[76:77], v9 offset0:192 offset1:193
    ds_read2_b32 v[78:79], v9 offset0:194 offset1:195
    v_mfma_f32_16x16x32_bf16 v[40:43], v[80:83], v[96:99], v[40:43]
    ds_read2_b32 v[80:81], v10 offset0:64 offset1:65
    ds_read2_b32 v[82:83], v10 offset0:66 offset1:67
    s_waitcnt lgkmcnt(15)
    v_mfma_f32_16x16x32_bf16 v[36:39], v[64:67], v[108:111], v[36:39]
    ds_read_b128 v[108:111], v12 offset:1728
    buffer_load_dwordx4 v[188:191], v1, s[16:19], s49 offen offset:3072 sc1
    s_add_u32 s50, s50, 4096
    s_and_b32 s50, s50, 0x7fff
    s_add_u32 s49, s48, s50
    v_mfma_f32_16x16x32_bf16 v[40:43], v[64:67], v[112:115], v[40:43]
    ds_read_b128 v[112:115], v12 offset:2240
    v_mfma_f32_16x16x32_bf16 v[44:47], v[92:95], v[96:99], v[44:47]
    ds_read2_b32 v[92:93], v11 offset0:192 offset1:193
    ds_read2_b32 v[94:95], v11 offset0:194 offset1:195
    v_mfma_f32_16x16x32_bf16 v[32:35], v[64:67], v[96:99], v[32:35]
    ds_read_b128 v[96:99], v12 offset:192
    v_mfma_f32_16x16x32_bf16 v[44:47], v[64:67], v[124:127], v[44:47]
    ds_read2_b32 v[64:65], v8 offset0:64 offset1:65
    ds_read2_b32 v[66:67], v8 offset0:66 offset1:67
    ds_read_b128 v[124:127], v12 offset:3776
    s_waitcnt lgkmcnt(15)
    v_mfma_f32_16x16x32_bf16 v[44:47], v[72:75], v[116:119], v[44:47]
    ds_read_b128 v[116:119], v12 offset:2688
    v_mfma_f32_16x16x32_bf16 v[40:43], v[72:75], v[104:107], v[40:43]
    buffer_load_dwordx4 v[192:195], v1, s[16:19], s49 offen offset:0 sc1
    v_mfma_f32_16x16x32_bf16 v[44:47], v[84:87], v[104:107], v[44:47]
    ds_read2_b32 v[84:85], v10 offset0:208 offset1:209
    ds_read2_b32 v[86:87], v10 offset0:210 offset1:211
    v_mfma_f32_16x16x32_bf16 v[36:39], v[72:75], v[100:103], v[36:39]
    ds_read2_b32 v[72:73], v9 offset0:80 offset1:81
    ds_read2_b32 v[74:75], v9 offset0:82 offset1:83
    v_mfma_f32_16x16x32_bf16 v[44:47], v[88:91], v[100:103], v[44:47]
    ds_read2_b32 v[88:89], v11 offset0:80 offset1:81
    ds_read2_b32 v[90:91], v11 offset0:82 offset1:83
    s_waitcnt lgkmcnt(15)
    v_mfma_f32_16x16x32_bf16 v[36:39], v[68:71], v[104:107], v[36:39]
    ds_read_b128 v[104:107], v12 offset:1152
    buffer_load_dwordx4 v[196:199], v1, s[16:19], s49 offen offset:1024 sc1
    v_mfma_f32_16x16x32_bf16 v[40:43], v[76:79], v[100:103], v[40:43]
    ds_read_b128 v[100:103], v12 offset:640
    v_mfma_f32_16x16x32_bf16 v[44:47], v[68:71], v[120:123], v[44:47]
    ds_read_b128 v[120:123], v12 offset:3200
    s_waitcnt lgkmcnt(15)
    v_mfma_f32_16x16x32_bf16 v[40:43], v[68:71], v[108:111], v[40:43]
    ds_read2_b32 v[68:69], v8 offset0:208 offset1:209
    ds_read2_b32 v[70:71], v8 offset0:210 offset1:211
    v_mfma_f32_16x16x32_bf16 v[44:47], v[80:83], v[108:111], v[44:47]
    buffer_load_dwordx4 v[200:203], v1, s[16:19], s49 offen offset:2048 sc1
    v_mfma_f32_16x16x32_bf16 v[44:47], v[76:79], v[112:115], v[44:47]
    s_waitcnt lgkmcnt(15)
    v_mfma_f32_16x16x32_bf16 v[36:39], v[76:79], v[96:99], v[36:39]
    ds_read2_b32 v[76:77], v9 offset0:208 offset1:209
    ds_read2_b32 v[78:79], v9 offset0:210 offset1:211
    v_mfma_f32_16x16x32_bf16 v[40:43], v[80:83], v[96:99], v[40:43]
    ds_read2_b32 v[80:81], v10 offset0:80 offset1:81
    ds_read2_b32 v[82:83], v10 offset0:82 offset1:83
    s_waitcnt lgkmcnt(15)
    v_mfma_f32_16x16x32_bf16 v[36:39], v[64:67], v[108:111], v[36:39]
    ds_read_b128 v[108:111], v12 offset:1664
    buffer_load_dwordx4 v[204:207], v1, s[16:19], s49 offen offset:3072 sc1
    s_add_u32 s50, s50, 4096
    s_and_b32 s50, s50, 0x7fff
    s_add_u32 s49, s48, s50
    v_mfma_f32_16x16x32_bf16 v[40:43], v[64:67], v[112:115], v[40:43]
    ds_read_b128 v[112:115], v12 offset:2176
    v_mfma_f32_16x16x32_bf16 v[44:47], v[92:95], v[96:99], v[44:47]
    ds_read2_b32 v[92:93], v11 offset0:208 offset1:209
    ds_read2_b32 v[94:95], v11 offset0:210 offset1:211
    v_mfma_f32_16x16x32_bf16 v[32:35], v[64:67], v[96:99], v[32:35]
    ds_read_b128 v[96:99], v12 offset:128
    v_mfma_f32_16x16x32_bf16 v[44:47], v[64:67], v[124:127], v[44:47]
    ds_read2_b32 v[64:65], v8 offset0:80 offset1:81
    ds_read2_b32 v[66:67], v8 offset0:82 offset1:83
    ds_read_b128 v[124:127], v12 offset:3712
    s_waitcnt lgkmcnt(15)
    v_mfma_f32_16x16x32_bf16 v[44:47], v[72:75], v[116:119], v[44:47]
    ds_read_b128 v[116:119], v12 offset:2624
    v_mfma_f32_16x16x32_bf16 v[40:43], v[72:75], v[104:107], v[40:43]
    buffer_load_dwordx4 v[208:211], v1, s[16:19], s49 offen offset:0 sc1
    v_mfma_f32_16x16x32_bf16 v[44:47], v[84:87], v[104:107], v[44:47]
    ds_read2_b32 v[84:85], v10 offset0:224 offset1:225
    ds_read2_b32 v[86:87], v10 offset0:226 offset1:227
    v_mfma_f32_16x16x32_bf16 v[36:39], v[72:75], v[100:103], v[36:39]
    ds_read2_b32 v[72:73], v9 offset0:96 offset1:97
    ds_read2_b32 v[74:75], v9 offset0:98 offset1:99
    v_mfma_f32_16x16x32_bf16 v[44:47], v[88:91], v[100:103], v[44:47]
    ds_read2_b32 v[88:89], v11 offset0:96 offset1:97
    ds_read2_b32 v[90:91], v11 offset0:98 offset1:99
    s_waitcnt lgkmcnt(15)
    v_mfma_f32_16x16x32_bf16 v[36:39], v[68:71], v[104:107], v[36:39]
    ds_read_b128 v[104:107], v12 offset:1088
    buffer_load_dwordx4 v[212:215], v1, s[16:19], s49 offen offset:1024 sc1
    v_mfma_f32_16x16x32_bf16 v[40:43], v[76:79], v[100:103], v[40:43]
    ds_read_b128 v[100:103], v12 offset:576
    v_mfma_f32_16x16x32_bf16 v[44:47], v[68:71], v[120:123], v[44:47]
    ds_read_b128 v[120:123], v12 offset:3136
    s_waitcnt lgkmcnt(15)
    v_mfma_f32_16x16x32_bf16 v[40:43], v[68:71], v[108:111], v[40:43]
    ds_read2_b32 v[68:69], v8 offset0:224 offset1:225
    ds_read2_b32 v[70:71], v8 offset0:226 offset1:227
    v_mfma_f32_16x16x32_bf16 v[44:47], v[80:83], v[108:111], v[44:47]
    buffer_load_dwordx4 v[216:219], v1, s[16:19], s49 offen offset:2048 sc1
    v_mfma_f32_16x16x32_bf16 v[44:47], v[76:79], v[112:115], v[44:47]
    s_waitcnt lgkmcnt(15)
    v_mfma_f32_16x16x32_bf16 v[36:39], v[76:79], v[96:99], v[36:39]
    ds_read2_b32 v[76:77], v9 offset0:224 offset1:225
    ds_read2_b32 v[78:79], v9 offset0:226 offset1:227
    v_mfma_f32_16x16x32_bf16 v[40:43], v[80:83], v[96:99], v[40:43]
    ds_read2_b32 v[80:81], v10 offset0:96 offset1:97
    ds_read2_b32 v[82:83], v10 offset0:98 offset1:99
    s_waitcnt lgkmcnt(15)
    v_mfma_f32_16x16x32_bf16 v[36:39], v[64:67], v[108:111], v[36:39]
    ds_read_b128 v[108:111], v12 offset:1600
    buffer_load_dwordx4 v[220:223], v1, s[16:19], s49 offen offset:3072 sc1
    s_add_u32 s50, s50, 4096
    s_and_b32 s50, s50, 0x7fff
    s_add_u32 s49, s48, s50
    v_mfma_f32_16x16x32_bf16 v[40:43], v[64:67], v[112:115], v[40:43]
    ds_read_b128 v[112:115], v12 offset:2112
    v_mfma_f32_16x16x32_bf16 v[44:47], v[92:95], v[96:99], v[44:47]
    ds_read2_b32 v[92:93], v11 offset0:224 offset1:225
    ds_read2_b32 v[94:95], v11 offset0:226 offset1:227
    v_mfma_f32_16x16x32_bf16 v[32:35], v[64:67], v[96:99], v[32:35]
    ds_read_b128 v[96:99], v12 offset:64
    v_mfma_f32_16x16x32_bf16 v[44:47], v[64:67], v[124:127], v[44:47]
    ds_read2_b32 v[64:65], v8 offset0:96 offset1:97
    ds_read2_b32 v[66:67], v8 offset0:98 offset1:99
    ds_read_b128 v[124:127], v12 offset:3648
    s_waitcnt lgkmcnt(15)
    v_mfma_f32_16x16x32_bf16 v[44:47], v[72:75], v[116:119], v[44:47]
    ds_read_b128 v[116:119], v12 offset:2560
    v_mfma_f32_16x16x32_bf16 v[40:43], v[72:75], v[104:107], v[40:43]
    buffer_load_dwordx4 v[224:227], v1, s[16:19], s49 offen offset:0 sc1
    v_mfma_f32_16x16x32_bf16 v[44:47], v[84:87], v[104:107], v[44:47]
    ds_read2_b32 v[84:85], v10 offset0:240 offset1:241
    ds_read2_b32 v[86:87], v10 offset0:242 offset1:243
    v_mfma_f32_16x16x32_bf16 v[36:39], v[72:75], v[100:103], v[36:39]
    ds_read2_b32 v[72:73], v9 offset0:112 offset1:113
    ds_read2_b32 v[74:75], v9 offset0:114 offset1:115
    v_mfma_f32_16x16x32_bf16 v[44:47], v[88:91], v[100:103], v[44:47]
    ds_read2_b32 v[88:89], v11 offset0:112 offset1:113
    ds_read2_b32 v[90:91], v11 offset0:114 offset1:115
    s_waitcnt lgkmcnt(15)
    v_mfma_f32_16x16x32_bf16 v[36:39], v[68:71], v[104:107], v[36:39]
    ds_read_b128 v[104:107], v12 offset:1024
    buffer_load_dwordx4 v[228:231], v1, s[16:19], s49 offen offset:1024 sc1
    v_mfma_f32_16x16x32_bf16 v[40:43], v[76:79], v[100:103], v[40:43]
    ds_read_b128 v[100:103], v12 offset:512
    v_mfma_f32_16x16x32_bf16 v[44:47], v[68:71], v[120:123], v[44:47]
    ds_read_b128 v[120:123], v12 offset:3072
    s_waitcnt lgkmcnt(15)
    v_mfma_f32_16x16x32_bf16 v[40:43], v[68:71], v[108:111], v[40:43]
    ds_read2_b32 v[68:69], v8 offset0:240 offset1:241
    ds_read2_b32 v[70:71], v8 offset0:242 offset1:243
    v_mfma_f32_16x16x32_bf16 v[44:47], v[80:83], v[108:111], v[44:47]
    buffer_load_dwordx4 v[232:235], v1, s[16:19], s49 offen offset:2048 sc1
    v_mfma_f32_16x16x32_bf16 v[44:47], v[76:79], v[112:115], v[44:47]
    s_waitcnt lgkmcnt(15)
    v_mfma_f32_16x16x32_bf16 v[36:39], v[76:79], v[96:99], v[36:39]
    ds_read2_b32 v[76:77], v9 offset0:240 offset1:241
    ds_read2_b32 v[78:79], v9 offset0:242 offset1:243
    v_mfma_f32_16x16x32_bf16 v[40:43], v[80:83], v[96:99], v[40:43]
    ds_read2_b32 v[80:81], v10 offset0:112 offset1:113
    ds_read2_b32 v[82:83], v10 offset0:114 offset1:115
    s_waitcnt lgkmcnt(15)
    v_mfma_f32_16x16x32_bf16 v[36:39], v[64:67], v[108:111], v[36:39]
    ds_read_b128 v[108:111], v12 offset:1536
    buffer_load_dwordx4 v[236:239], v1, s[16:19], s49 offen offset:3072 sc1
    s_add_u32 s50, s50, 4096
    s_and_b32 s50, s50, 0x7fff
    s_add_u32 s49, s48, s50
    v_mfma_f32_16x16x32_bf16 v[40:43], v[64:67], v[112:115], v[40:43]
    ds_read_b128 v[112:115], v12 offset:2048
    v_mfma_f32_16x16x32_bf16 v[44:47], v[92:95], v[96:99], v[44:47]
    ds_read2_b32 v[92:93], v11 offset0:240 offset1:241
    ds_read2_b32 v[94:95], v11 offset0:242 offset1:243
    v_mfma_f32_16x16x32_bf16 v[32:35], v[64:67], v[96:99], v[32:35]
    ds_read_b128 v[96:99], v12 offset:0
    v_mfma_f32_16x16x32_bf16 v[44:47], v[64:67], v[124:127], v[44:47]
    ds_read2_b32 v[64:65], v8 offset0:112 offset1:113
    ds_read2_b32 v[66:67], v8 offset0:114 offset1:115
    ds_read_b128 v[124:127], v12 offset:3584
    s_waitcnt lgkmcnt(15)
    v_mfma_f32_16x16x32_bf16 v[44:47], v[72:75], v[116:119], v[44:47]
    v_mfma_f32_16x16x32_bf16 v[40:43], v[72:75], v[104:107], v[40:43]
    buffer_load_dwordx4 v[240:243], v1, s[16:19], s49 offen offset:0 sc1
    v_mfma_f32_16x16x32_bf16 v[44:47], v[84:87], v[104:107], v[44:47]
    v_mfma_f32_16x16x32_bf16 v[36:39], v[72:75], v[100:103], v[36:39]
    v_mfma_f32_16x16x32_bf16 v[44:47], v[88:91], v[100:103], v[44:47]
    s_waitcnt lgkmcnt(12)
    v_mfma_f32_16x16x32_bf16 v[36:39], v[68:71], v[104:107], v[36:39]
    buffer_load_dwordx4 v[244:247], v1, s[16:19], s49 offen offset:1024 sc1
    s_waitcnt lgkmcnt(10)
    v_mfma_f32_16x16x32_bf16 v[40:43], v[76:79], v[100:103], v[40:43]
    v_mfma_f32_16x16x32_bf16 v[44:47], v[68:71], v[120:123], v[44:47]
    s_waitcnt lgkmcnt(7)
    v_mfma_f32_16x16x32_bf16 v[40:43], v[68:71], v[108:111], v[40:43]
    v_mfma_f32_16x16x32_bf16 v[44:47], v[80:83], v[108:111], v[44:47]
    buffer_load_dwordx4 v[248:251], v1, s[16:19], s49 offen offset:2048 sc1
    s_waitcnt lgkmcnt(6)
    v_mfma_f32_16x16x32_bf16 v[44:47], v[76:79], v[112:115], v[44:47]
    s_waitcnt lgkmcnt(3)
    v_mfma_f32_16x16x32_bf16 v[36:39], v[76:79], v[96:99], v[36:39]
    v_mfma_f32_16x16x32_bf16 v[40:43], v[80:83], v[96:99], v[40:43]
    s_waitcnt lgkmcnt(1)
    v_mfma_f32_16x16x32_bf16 v[36:39], v[64:67], v[108:111], v[36:39]
    buffer_load_dwordx4 v[252:255], v1, s[16:19], s49 offen offset:3072 sc1
    s_add_u32 s50, s50, 4096
    s_and_b32 s50, s50, 0x7fff
    s_add_u32 s49, s48, s50
    v_mfma_f32_16x16x32_bf16 v[40:43], v[64:67], v[112:115], v[40:43]
    v_mfma_f32_16x16x32_bf16 v[44:47], v[92:95], v[96:99], v[44:47]
    v_mfma_f32_16x16x32_bf16 v[32:35], v[64:67], v[96:99], v[32:35]
    s_waitcnt lgkmcnt(0)
    v_mfma_f32_16x16x32_bf16 v[44:47], v[64:67], v[124:127], v[44:47]
    ds_read_b64 v[64:65], v14 offset:512
    ds_read_b64 v[66:67], v14 offset:2048
    ds_read_b64 v[68:69], v14 offset:2560
    ds_read_b64 v[70:71], v14 offset:4096
    s_branch h_conv_epi
h_conv1:
    ds_read2_b32 v[64:65], v8 offset0:0 offset1:1
    ds_read2_b32 v[66:67], v8 offset0:2 offset1:3
    ds_read_b128 v[120:123], v12 offset:3520
    ds_read_b128 v[104:107], v12 offset:1472
    ds_read2_b32 v[76:77], v9 offset0:128 offset1:129
    ds_read2_b32 v[78:79], v9 offset0:130 offset1:131
    ds_read2_b32 v[80:81], v10 offset0:0 offset1:1
    ds_read2_b32 v[82:83], v10 offset0:2 offset1:3
    ds_read_b128 v[116:119], v12 offset:3008
    ds_read_b128 v[100:103], v12 offset:960
    ds_read_b128 v[108:111], v12 offset:1984
    ds_read2_b32 v[68:69], v8 offset0:128 offset1:129
    ds_read2_b32 v[70:71], v8 offset0:130 offset1:131
    ds_read2_b32 v[84:85], v10 offset0:128 offset1:129
    ds_read2_b32 v[86:87], v10 offset0:130 offset1:131
    ds_read2_b32 v[72:73], v9 offset0:0 offset1:1
    ds_read2_b32 v[74:75], v9 offset0:2 offset1:3
    ds_read_b128 v[112:115], v12 offset:2496
    ds_read_b128 v[96:99], v12 offset:448
    ds_read2_b32 v[88:89], v11 offset0:0 offset1:1
    ds_read2_b32 v[90:91], v11 offset0:2 offset1:3
    s_waitcnt lgkmcnt(15)
    v_mfma_f32_16x16x32_bf16 v[44:47], v[64:67], v[120:123], 0
    ds_read_b128 v[120:123], v12 offset:3456
    v_mfma_f32_16x16x32_bf16 v[36:39], v[64:67], v[104:107], 0
    buffer_load_dwordx4 v[128:131], v1, s[16:19], s49 offen offset:0 sc1
    v_mfma_f32_16x16x32_bf16 v[40:43], v[76:79], v[104:107], 0
    s_waitcnt lgkmcnt(14)
    v_mfma_f32_16x16x32_bf16 v[44:47], v[80:83], v[104:107], v[44:47]
    ds_read_b128 v[104:107], v12 offset:1408
    s_waitcnt lgkmcnt(14)
    v_mfma_f32_16x16x32_bf16 v[40:43], v[64:67], v[116:119], v[40:43]
    s_waitcnt lgkmcnt(13)
    v_mfma_f32_16x16x32_bf16 v[32:35], v[64:67], v[100:103], 0
    ds_read2_b32 v[64:65], v8 offset0:16 offset1:17
    ds_read2_b32 v[66:67], v8 offset0:18 offset1:19
    buffer_load_dwordx4 v[132:135], v1, s[16:19], s49 offen offset:1024 sc1
    v_mfma_f32_16x16x32_bf16 v[40:43], v[80:83], v[100:103], v[40:43]
    ds_read2_b32 v[80:81], v10 offset0:16 offset1:17
    ds_read2_b32 v[82:83], v10 offset0:18 offset1:19
    s_waitcnt lgkmcnt(15)
    v_mfma_f32_16x16x32_bf16 v[44:47], v[76:79], v[108:111], v[44:47]
    ds_read2_b32 v[76:77], v9 offset0:144 offset1:145
    ds_read2_b32 v[78:79], v9 offset0:146 offset1:147
    s_waitcnt lgkmcnt(15)
    v_mfma_f32_16x16x32_bf16 v[44:47], v[68:71], v[116:119], v[44:47]
    ds_read_b128 v[116:119], v12 offset:2944
    v_mfma_f32_16x16x32_bf16 v[36:39], v[68:71], v[100:103], v[36:39]
    buffer_load_dwordx4 v[136:139], v1, s[16:19], s49 offen offset:2048 sc1
    s_waitcnt lgkmcnt(15)
    v_mfma_f32_16x16x32_bf16 v[44:47], v[84:87], v[100:103], v[44:47]
    ds_read_b128 v[100:103], v12 offset:896
    s_waitcnt lgkmcnt(14)
    v_mfma_f32_16x16x32_bf16 v[40:43], v[72:75], v[108:111], v[40:43]
    ds_read_b128 v[108:111], v12 offset:1920
    s_waitcnt lgkmcnt(14)
    v_mfma_f32_16x16x32_bf16 v[40:43], v[68:71], v[112:115], v[40:43]
    s_waitcnt lgkmcnt(13)
    v_mfma_f32_16x16x32_bf16 v[32:35], v[68:71], v[96:99], v[32:35]
    ds_read2_b32 v[68:69], v8 offset0:144 offset1:145
    ds_read2_b32 v[70:71], v8 offset0:146 offset1:147
    buffer_load_dwordx4 v[140:143], v1, s[16:19], s49 offen offset:3072 sc1
    s_add_u32 s50, s50, 4096
    s_and_b32 s50, s50, 0x7fff
    s_add_u32 s49, s48, s50
    v_mfma_f32_16x16x32_bf16 v[40:43], v[84:87], v[96:99], v[40:43]
    ds_read2_b32 v[84:85], v10 offset0:144 offset1:145
    ds_read2_b32 v[86:87], v10 offset0:146 offset1:147
    v_mfma_f32_16x16x32_bf16 v[44:47], v[72:75], v[112:115], v[44:47]
    ds_read_b128 v[112:115], v12 offset:2432
    v_mfma_f32_16x16x32_bf16 v[36:39], v[72:75], v[96:99], v[36:39]
    ds_read2_b32 v[72:73], v9 offset0:16 offset1:17
    ds_read2_b32 v[74:75], v9 offset0:18 offset1:19
    s_waitcnt lgkmcnt(15)
    v_mfma_f32_16x16x32_bf16 v[44:47], v[88:91], v[96:99], v[44:47]
    ds_read2_b32 v[88:89], v11 offset0:16 offset1:17
    ds_read2_b32 v[90:91], v11 offset0:18 offset1:19
    ds_read_b128 v[96:99], v12 offset:384
    s_waitcnt lgkmcnt(15)
    v_mfma_f32_16x16x32_bf16 v[44:47], v[64:67], v[120:123], v[44:47]
    ds_read_b128 v[120:123], v12 offset:3392
    v_mfma_f32_16x16x32_bf16 v[36:39], v[64:67], v[104:107], v[36:39]
    buffer_load_dwordx4 v[144:147], v1, s[16:19], s49 offen offset:0 sc1
    s_waitcnt lgkmcnt(14)
    v_mfma_f32_16x16x32_bf16 v[40:43], v[76:79], v[104:107], v[40:43]
    v_mfma_f32_16x16x32_bf16 v[44:47], v[80:83], v[104:107], v[44:47]
    ds_read_b128 v[104:107], v12 offset:1344
    s_waitcnt lgkmcnt(14)
    v_mfma_f32_16x16x32_bf16 v[40:43], v[64:67], v[116:119], v[40:43]
    s_waitcnt lgkmcnt(13)
    v_mfma_f32_16x16x32_bf16 v[32:35], v[64:67], v[100:103], v[32:35]
    ds_read2_b32 v[64:65], v8 offset0:32 offset1:33
    ds_read2_b32 v[66:67], v8 offset0:34 offset1:35
    buffer_load_dwordx4 v[148:151], v1, s[16:19], s49 offen offset:1024 sc1
    v_mfma_f32_16x16x32_bf16 v[40:43], v[80:83], v[100:103], v[40:43]
    ds_read2_b32 v[80:81], v10 offset0:32 offset1:33
    ds_read2_b32 v[82:83], v10 offset0:34 offset1:35
    s_waitcnt lgkmcnt(15)
    v_mfma_f32_16x16x32_bf16 v[44:47], v[76:79], v[108:111], v[44:47]
    ds_read2_b32 v[76:77], v9 offset0:160 offset1:161
    ds_read2_b32 v[78:79], v9 offset0:162 offset1:163
    s_waitcnt lgkmcnt(15)
    v_mfma_f32_16x16x32_bf16 v[44:47], v[68:71], v[116:119], v[44:47]
    ds_read_b128 v[116:119], v12 offset:2880
    v_mfma_f32_16x16x32_bf16 v[36:39], v[68:71], v[100:103], v[36:39]
    buffer_load_dwordx4 v[152:155], v1, s[16:19], s49 offen offset:2048 sc1
    s_waitcnt lgkmcnt(15)
    v_mfma_f32_16x16x32_bf16 v[44:47], v[84:87], v[100:103], v[44:47]
    ds_read_b128 v[100:103], v12 offset:832
    s_waitcnt lgkmcnt(13)
    v_mfma_f32_16x16x32_bf16 v[40:43], v[72:75], v[108:111], v[40:43]
    ds_read_b128 v[108:111], v12 offset:1856
    v_mfma_f32_16x16x32_bf16 v[40:43], v[68:71], v[112:115], v[40:43]
    s_waitcnt lgkmcnt(11)
    v_mfma_f32_16x16x32_bf16 v[32:35], v[68:71], v[96:99], v[32:35]
    ds_read2_b32 v[68:69], v8 offset0:160 offset1:161
    ds_read2_b32 v[70:71], v8 offset0:162 offset1:163
    buffer_load_dwordx4 v[156:159], v1, s[16:19], s49 offen offset:3072 sc1
    s_add_u32 s50, s50, 4096
    s_and_b32 s50, s50, 0x7fff
    s_add_u32 s49, s48, s50
    v_mfma_f32_16x16x32_bf16 v[40:43], v[84:87], v[96:99], v[40:43]
    ds_read2_b32 v[84:85], v10 offset0:160 offset1:161
    ds_read2_b32 v[86:87], v10 offset0:162 offset1:163
    v_mfma_f32_16x16x32_bf16 v[44:47], v[72:75], v[112:115], v[44:47]
    ds_read_b128 v[112:115], v12 offset:2368
    v_mfma_f32_16x16x32_bf16 v[36:39], v[72:75], v[96:99], v[36:39]
    ds_read2_b32 v[72:73], v9 offset0:32 offset1:33
    ds_read2_b32 v[74:75], v9 offset0:34 offset1:35
    v_mfma_f32_16x16x32_bf16 v[44:47], v[88:91], v[96:99], v[44:47]
    ds_read2_b32 v[88:89], v11 offset0:32 offset1:33
    ds_read2_b32 v[90:91], v11 offset0:34 offset1:35
    ds_read_b128 v[96:99], v12 offset:320
    s_waitcnt lgkmcnt(15)
    v_mfma_f32_16x16x32_bf16 v[44:47], v[64:67], v[120:123], v[44:47]
    ds_read_b128 v[120:123], v12 offset:3328
    v_mfma_f32_16x16x32_bf16 v[36:39], v[64:67], v[104:107], v[36:39]
    buffer_load_dwordx4 v[160:163], v1, s[16:19], s49 offen offset:0 sc1
    s_waitcnt lgkmcnt(14)
    v_mfma_f32_16x16x32_bf16 v[40:43], v[76:79], v[104:107], v[40:43]
    v_mfma_f32_16x16x32_bf16 v[44:47], v[80:83], v[104:107], v[44:47]
    ds_read_b128 v[104:107], v12 offset:1280
    s_waitcnt lgkmcnt(14)
    v_mfma_f32_16x16x32_bf16 v[40:43], v[64:67], v[116:119], v[40:43]
    s_waitcnt lgkmcnt(13)
    v_mfma_f32_16x16x32_bf16 v[32:35], v[64:67], v[100:103], v[32:35]
    ds_read2_b32 v[64:65], v8 offset0:48 offset1:49
    ds_read2_b32 v[66:67], v8 offset0:50 offset1:51
    buffer_load_dwordx4 v[164:167], v1, s[16:19], s49 offen offset:1024 sc1
    v_mfma_f32_16x16x32_bf16 v[40:43], v[80:83], v[100:103], v[40:43]
    ds_read2_b32 v[80:81], v10 offset0:48 offset1:49
    ds_read2_b32 v[82:83], v10 offset0:50 offset1:51
    s_waitcnt lgkmcnt(15)
    v_mfma_f32_16x16x32_bf16 v[44:47], v[76:79], v[108:111], v[44:47]
    ds_read2_b32 v[76:77], v9 offset0:176 offset1:177
    ds_read2_b32 v[78:79], v9 offset0:178 offset1:179
    s_waitcnt lgkmcnt(15)
    v_mfma_f32_16x16x32_bf16 v[44:47], v[68:71], v[116:119], v[44:47]
    ds_read_b128 v[116:119], v12 offset:2816
    v_mfma_f32_16x16x32_bf16 v[36:39], v[68:71], v[100:103], v[36:39]
    buffer_load_dwordx4 v[168:171], v1, s[16:19], s49 offen offset:2048 sc1
    s_waitcnt lgkmcnt(15)
    v_mfma_f32_16x16x32_bf16 v[44:47], v[84:87], v[100:103], v[44:47]
    ds_read_b128 v[100:103], v12 offset:768
    s_waitcnt lgkmcnt(13)
    v_mfma_f32_16x16x32_bf16 v[40:43], v[72:75], v[108:111], v[40:43]
    ds_read_b128 v[108:111], v12 offset:1792
    v_mfma_f32_16x16x32_bf16 v[40:43], v[68:71], v[112:115], v[40:43]
    s_waitcnt lgkmcnt(11)
    v_mfma_f32_16x16x32_bf16 v[32:35], v[68:71], v[96:99], v[32:35]
    ds_read2_b32 v[68:69], v8 offset0:176 offset1:177
    ds_read2_b32 v[70:71], v8 offset0:178 offset1:179
    buffer_load_dwordx4 v[172:175], v1, s[16:19], s49 offen offset:3072 sc1
    s_add_u32 s50, s50, 4096
    s_and_b32 s50, s50, 0x7fff
    s_add_u32 s49, s48, s50
    v_mfma_f32_16x16x32_bf16 v[40:43], v[84:87], v[96:99], v[40:43]
    ds_read2_b32 v[84:85], v10 offset0:176 offset1:177
    ds_read2_b32 v[86:87], v10 offset0:178 offset1:179
    v_mfma_f32_16x16x32_bf16 v[44:47], v[72:75], v[112:115], v[44:47]
    ds_read_b128 v[112:115], v12 offset:2304
    v_mfma_f32_16x16x32_bf16 v[36:39], v[72:75], v[96:99], v[36:39]
    ds_read2_b32 v[72:73], v9 offset0:48 offset1:49
    ds_read2_b32 v[74:75], v9 offset0:50 offset1:51
    v_mfma_f32_16x16x32_bf16 v[44:47], v[88:91], v[96:99], v[44:47]
    ds_read2_b32 v[88:89], v11 offset0:48 offset1:49
    ds_read2_b32 v[90:91], v11 offset0:50 offset1:51
    ds_read_b128 v[96:99], v12 offset:256
    s_waitcnt lgkmcnt(15)
    v_mfma_f32_16x16x32_bf16 v[44:47], v[64:67], v[120:123], v[44:47]
    ds_read_b128 v[120:123], v12 offset:3264
    v_mfma_f32_16x16x32_bf16 v[36:39], v[64:67], v[104:107], v[36:39]
    buffer_load_dwordx4 v[176:179], v1, s[16:19], s49 offen offset:0 sc1
    s_waitcnt lgkmcnt(14)
    v_mfma_f32_16x16x32_bf16 v[40:43], v[76:79], v[104:107], v[40:43]
    v_mfma_f32_16x16x32_bf16 v[44:47], v[80:83], v[104:107], v[44:47]
    ds_read_b128 v[104:107], v12 offset:1216
    s_waitcnt lgkmcnt(14)
    v_mfma_f32_16x16x32_bf16 v[40:43], v[64:67], v[116:119], v[40:43]
    s_waitcnt lgkmcnt(13)
    v_mfma_f32_16x16x32_bf16 v[32:35], v[64:67], v[100:103], v[32:35]
    ds_read2_b32 v[64:65], v8 offset0:64 offset1:65
    ds_read2_b32 v[66:67], v8 offset0:66 offset1:67
    buffer_load_dwordx4 v[180:183], v1, s[16:19], s49 offen offset:1024 sc1
    v_mfma_f32_16x16x32_bf16 v[40:43], v[80:83], v[100:103], v[40:43]
    ds_read2_b32 v[80:81], v10 offset0:64 offset1:65
    ds_read2_b32 v[82:83], v10 offset0:66 offset1:67
    s_waitcnt lgkmcnt(15)
    v_mfma_f32_16x16x32_bf16 v[44:47], v[76:79], v[108:111], v[44:47]
    ds_read2_b32 v[76:77], v9 offset0:192 offset1:193
    ds_read2_b32 v[78:79], v9 offset0:194 offset1:195
    s_waitcnt lgkmcnt(15)
    v_mfma_f32_16x16x32_bf16 v[44:47], v[68:71], v[116:119], v[44:47]
    ds_read_b128 v[116:119], v12 offset:2752
    v_mfma_f32_16x16x32_bf16 v[36:39], v[68:71], v[100:103], v[36:39]
    buffer_load_dwordx4 v[184:187], v1, s[16:19], s49 offen offset:2048 sc1
    s_waitcnt lgkmcnt(15)
    v_mfma_f32_16x16x32_bf16 v[44:47], v[84:87], v[100:103], v[44:47]
    ds_read_b128 v[100:103], v12 offset:704
    s_waitcnt lgkmcnt(13)
    v_mfma_f32_16x16x32_bf16 v[40:43], v[72:75], v[108:111], v[40:43]
    ds_read_b128 v[108:111], v12 offset:1728
    v_mfma_f32_16x16x32_bf16 v[40:43], v[68:71], v[112:115], v[40:43]
    s_waitcnt lgkmcnt(11)
    v_mfma_f32_16x16x32_bf16 v[32:35], v[68:71], v[96:99], v[32:35]
    ds_read2_b32 v[68:69], v8 offset0:192 offset1:193
    ds_read2_b32 v[70:71], v8 offset0:194 offset1:195
    buffer_load_dwordx4 v[188:191], v1, s[16:19], s49 offen offset:3072 sc1
    s_add_u32 s50, s50, 4096
    s_and_b32 s50, s50, 0x7fff
    s_add_u32 s49, s48, s50
    v_mfma_f32_16x16x32_bf16 v[40:43], v[84:87], v[96:99], v[40:43]
    ds_read2_b32 v[84:85], v10 offset0:192 offset1:193
    ds_read2_b32 v[86:87], v10 offset0:194 offset1:195
    v_mfma_f32_16x16x32_bf16 v[44:47], v[72:75], v[112:115], v[44:47]
    ds_read_b128 v[112:115], v12 offset:2240
    v_mfma_f32_16x16x32_bf16 v[36:39], v[72:75], v[96:99], v[36:39]
    ds_read2_b32 v[72:73], v9 offset0:64 offset1:65
    ds_read2_b32 v[74:75], v9 offset0:66 offset1:67
    v_mfma_f32_16x16x32_bf16 v[44:47], v[88:91], v[96:99], v[44:47]
    ds_read2_b32 v[88:89], v11 offset0:64 offset1:65
    ds_read2_b32 v[90:91], v11 offset0:66 offset1:67
    ds_read_b128 v[96:99], v12 offset:192
    s_waitcnt lgkmcnt(15)
    v_mfma_f32_16x16x32_bf16 v[44:47], v[64:67], v[120:123], v[44:47]
    ds_read_b128 v[120:123], v12 offset:3200
    v_mfma_f32_16x16x32_bf16 v[36:39], v[64:67], v[104:107], v[36:39]
    buffer_load_dwordx4 v[192:195], v1, s[16:19], s49 offen offset:0 sc1
    s_waitcnt lgkmcnt(14)
    v_mfma_f32_16x16x32_bf16 v[40:43], v[76:79], v[104:107], v[40:43]
    v_mfma_f32_16x16x32_bf16 v[44:47], v[80:83], v[104:107], v[44:47]
    ds_read_b128 v[104:107], v12 offset:1152
    s_waitcnt lgkmcnt(14)
    v_mfma_f32_16x16x32_bf16 v[40:43], v[64:67], v[116:119], v[40:43]
    s_waitcnt lgkmcnt(13)
    v_mfma_f32_16x16x32_bf16 v[32:35], v[64:67], v[100:103], v[32:35]
    ds_read2_b32 v[64:65], v8 offset0:80 offset1:81
    ds_read2_b32 v[66:67], v8 offset0:82 offset1:83
    buffer_load_dwordx4 v[196:199], v1, s[16:19], s49 offen offset:1024 sc1
    v_mfma_f32_16x16x32_bf16 v[40:43], v[80:83], v[100:103], v[40:43]
    ds_read2_b32 v[80:81], v10 offset0:80 offset1:81
    ds_read2_b32 v[82:83], v10 offset0:82 offset1:83
    s_waitcnt lgkmcnt(15)
    v_mfma_f32_16x16x32_bf16 v[44:47], v[76:79], v[108:111], v[44:47]
    ds_read2_b32 v[76:77], v9 offset0:208 offset1:209
    ds_read2_b32 v[78:79], v9 offset0:210 offset1:211
    s_waitcnt lgkmcnt(15)
    v_mfma_f32_16x16x32_bf16 v[44:47], v[68:71], v[116:119], v[44:47]
    ds_read_b128 v[116:119], v12 offset:2688
    v_mfma_f32_16x16x32_bf16 v[36:39], v[68:71], v[100:103], v[36:39]
    buffer_load_dwordx4 v[200:203], v1, s[16:19], s49 offen offset:2048 sc1
    s_waitcnt lgkmcnt(15)
    v_mfma_f32_16x16x32_bf16 v[44:47], v[84:87], v[100:103], v[44:47]
    ds_read_b128 v[100:103], v12 offset:640
    s_waitcnt lgkmcnt(13)
    v_mfma_f32_16x16x32_bf16 v[40:43], v[72:75], v[108:111], v[40:43]
    ds_read_b128 v[108:111], v12 offset:1664
    v_mfma_f32_16x16x32_bf16 v[40:43], v[68:71], v[112:115], v[40:43]
    s_waitcnt lgkmcnt(11)
    v_mfma_f32_16x16x32_bf16 v[32:35], v[68:71], v[96:99], v[32:35]
    ds_read2_b32 v[68:69], v8 offset0:208 offset1:209
    ds_read2_b32 v[70:71], v8 offset0:210 offset1:211
    buffer_load_dwordx4 v[204:207], v1, s[16:19], s49 offen offset:3072 sc1
    s_add_u32 s50, s50, 4096
    s_and_b32 s50, s50, 0x7fff
    s_add_u32 s49, s48, s50
    v_mfma_f32_16x16x32_bf16 v[40:43], v[84:87], v[96:99], v[40:43]
    ds_read2_b32 v[84:85], v10 offset0:208 offset1:209
    ds_read2_b32 v[86:87], v10 offset0:210 offset1:211
    v_mfma_f32_16x16x32_bf16 v[44:47], v[72:75], v[112:115], v[44:47]
    ds_read_b128 v[112:115], v12 offset:2176
    v_mfma_f32_16x16x32_bf16 v[36:39], v[72:75], v[96:99], v[36:39]
    ds_read2_b32 v[72:73], v9 offset0:80 offset1:81
    ds_read2_b32 v[74:75], v9 offset0:82 offset1:83
    v_mfma_f32_16x16x32_bf16 v[44:47], v[88:91], v[96:99], v[44:47]
    ds_read2_b32 v[88:89], v11 offset0:80 offset1:81
    ds_read2_b32 v[90:91], v11 offset0:82 offset1:83
    ds_read_b128 v[96:99], v12 offset:128
    s_waitcnt lgkmcnt(15)
    v_mfma_f32_16x16x32_bf16 v[44:47], v[64:67], v[120:123], v[44:47]
    ds_read_b128 v[120:123], v12 offset:3136
    v_mfma_f32_16x16x32_bf16 v[36:39], v[64:67], v[104:107], v[36:39]
    buffer_load_dwordx4 v[208:211], v1, s[16:19], s49 offen offset:0 sc1
    s_waitcnt lgkmcnt(14)
    v_mfma_f32_16x16x32_bf16 v[40:43], v[76:79], v[104:107], v[40:43]
    v_mfma_f32_16x16x32_bf16 v[44:47], v[80:83], v[104:107], v[44:47]
    ds_read_b128 v[104:107], v12 offset:1088
    s_waitcnt lgkmcnt(14)
    v_mfma_f32_16x16x32_bf16 v[40:43], v[64:67], v[116:119], v[40:43]
    s_waitcnt lgkmcnt(13)
    v_mfma_f32_16x16x32_bf16 v[32:35], v[64:67], v[100:103], v[32:35]
    ds_read2_b32 v[64:65], v8 offset0:96 offset1:97
    ds_read2_b32 v[66:67], v8 offset0:98 offset1:99
    buffer_load_dwordx4 v[212:215], v1, s[16:19], s49 offen offset:1024 sc1
    v_mfma_f32_16x16x32_bf16 v[40:43], v[80:83], v[100:103], v[40:43]
    ds_read2_b32 v[80:81], v10 offset0:96 offset1:97
    ds_read2_b32 v[82:83], v10 offset0:98 offset1:99
    s_waitcnt lgkmcnt(15)
    v_mfma_f32_16x16x32_bf16 v[44:47], v[76:79], v[108:111], v[44:47]
    ds_read2_b32 v[76:77], v9 offset0:224 offset1:225
    ds_read2_b32 v[78:79], v9 offset0:226 offset1:227
    s_waitcnt lgkmcnt(15)
    v_mfma_f32_16x16x32_bf16 v[44:47], v[68:71], v[116:119], v[44:47]
    ds_read_b128 v[116:119], v12 offset:2624
    v_mfma_f32_16x16x32_bf16 v[36:39], v[68:71], v[100:103], v[36:39]
    buffer_load_dwordx4 v[216:219], v1, s[16:19], s49 offen offset:2048 sc1
    s_waitcnt lgkmcnt(15)
    v_mfma_f32_16x16x32_bf16 v[44:47], v[84:87], v[100:103], v[44:47]
    ds_read_b128 v[100:103], v12 offset:576
    s_waitcnt lgkmcnt(13)
    v_mfma_f32_16x16x32_bf16 v[40:43], v[72:75], v[108:111], v[40:43]
    ds_read_b128 v[108:111], v12 offset:1600
    v_mfma_f32_16x16x32_bf16 v[40:43], v[68:71], v[112:115], v[40:43]
    s_waitcnt lgkmcnt(11)
    v_mfma_f32_16x16x32_bf16 v[32:35], v[68:71], v[96:99], v[32:35]
    ds_read2_b32 v[68:69], v8 offset0:224 offset1:225
    ds_read2_b32 v[70:71], v8 offset0:226 offset1:227
    buffer_load_dwordx4 v[220:223], v1, s[16:19], s49 offen offset:3072 sc1
    s_add_u32 s50, s50, 4096
    s_and_b32 s50, s50, 0x7fff
    s_add_u32 s49, s48, s50
    v_mfma_f32_16x16x32_bf16 v[40:43], v[84:87], v[96:99], v[40:43]
    ds_read2_b32 v[84:85], v10 offset0:224 offset1:225
    ds_read2_b32 v[86:87], v10 offset0:226 offset1:227
    v_mfma_f32_16x16x32_bf16 v[44:47], v[72:75], v[112:115], v[44:47]
    ds_read_b128 v[112:115], v12 offset:2112
    v_mfma_f32_16x16x32_bf16 v[36:39], v[72:75], v[96:99], v[36:39]
    ds_read2_b32 v[72:73], v9 offset0:96 offset1:97
    ds_read2_b32 v[74:75], v9 offset0:98 offset1:99
    v_mfma_f32_16x16x32_bf16 v[44:47], v[88:91], v[96:99], v[44:47]
    ds_read2_b32 v[88:89], v11 offset0:96 offset1:97
    ds_read2_b32 v[90:91], v11 offset0:98 offset1:99
    ds_read_b128 v[96:99], v12 offset:64
    s_waitcnt lgkmcnt(15)
    v_mfma_f32_16x16x32_bf16 v[44:47], v[64:67], v[120:123], v[44:47]
    ds_read_b128 v[120:123], v12 offset:3072
    v_mfma_f32_16x16x32_bf16 v[36:39], v[64:67], v[104:107], v[36:39]
    buffer_load_dwordx4 v[224:227], v1, s[16:19], s49 offen offset:0 sc1
    s_waitcnt lgkmcnt(14)
    v_mfma_f32_16x16x32_bf16 v[40:43], v[76:79], v[104:107], v[40:43]
    v_mfma_f32_16x16x32_bf16 v[44:47], v[80:83], v[104:107], v[44:47]
    ds_read_b128 v[104:107], v12 offset:1024
    s_waitcnt lgkmcnt(14)
    v_mfma_f32_16x16x32_bf16 v[40:43], v[64:67], v[116:119], v[40:43]
    s_waitcnt lgkmcnt(13)
    v_mfma_f32_16x16x32_bf16 v[32:35], v[64:67], v[100:103], v[32:35]
    ds_read2_b32 v[64:65], v8 offset0:112 offset1:113
    ds_read2_b32 v[66:67], v8 offset0:114 offset1:115
    buffer_load_dwordx4 v[228:231], v1, s[16:19], s49 offen offset:1024 sc1
    v_mfma_f32_16x16x32_bf16 v[40:43], v[80:83], v[100:103], v[40:43]
    ds_read2_b32 v[80:81], v10 offset0:112 offset1:113
    ds_read2_b32 v[82:83], v10 offset0:114 offset1:115
    s_waitcnt lgkmcnt(15)
    v_mfma_f32_16x16x32_bf16 v[44:47], v[76:79], v[108:111], v[44:47]
    ds_read2_b32 v[76:77], v9 offset0:240 offset1:241
    ds_read2_b32 v[78:79], v9 offset0:242 offset1:243
    s_waitcnt lgkmcnt(15)
    v_mfma_f32_16x16x32_bf16 v[44:47], v[68:71], v[116:119], v[44:47]
    ds_read_b128 v[116:119], v12 offset:2560
    v_mfma_f32_16x16x32_bf16 v[36:39], v[68:71], v[100:103], v[36:39]
    buffer_load_dwordx4 v[232:235], v1, s[16:19], s49 offen offset:2048 sc1
    s_waitcnt lgkmcnt(15)
    v_mfma_f32_16x16x32_bf16 v[44:47], v[84:87], v[100:103], v[44:47]
    ds_read_b128 v[100:103], v12 offset:512
    s_waitcnt lgkmcnt(13)
    v_mfma_f32_16x16x32_bf16 v[40:43], v[72:75], v[108:111], v[40:43]
    ds_read_b128 v[108:111], v12 offset:1536
    v_mfma_f32_16x16x32_bf16 v[40:43], v[68:71], v[112:115], v[40:43]
    s_waitcnt lgkmcnt(11)
    v_mfma_f32_16x16x32_bf16 v[32:35], v[68:71], v[96:99], v[32:35]
    ds_read2_b32 v[68:69], v8 offset0:240 offset1:241
    ds_read2_b32 v[70:71], v8 offset0:242 offset1:243
    buffer_load_dwordx4 v[236:239], v1, s[16:19], s49 offen offset:3072 sc1
    s_add_u32 s50, s50, 4096
    s_and_b32 s50, s50, 0x7fff
    s_add_u32 s49, s48, s50
    v_mfma_f32_16x16x32_bf16 v[40:43], v[84:87], v[96:99], v[40:43]
    ds_read2_b32 v[84:85], v10 offset0:240 offset1:241
    ds_read2_b32 v[86:87], v10 offset0:242 offset1:243
    v_mfma_f32_16x16x32_bf16 v[44:47], v[72:75], v[112:115], v[44:47]
    ds_read_b128 v[112:115], v12 offset:2048
    v_mfma_f32_16x16x32_bf16 v[36:39], v[72:75], v[96:99], v[36:39]
    ds_read2_b32 v[72:73], v9 offset0:112 offset1:113
    ds_read2_b32 v[74:75], v9 offset0:114 offset1:115
    v_mfma_f32_16x16x32_bf16 v[44:47], v[88:91], v[96:99], v[44:47]
    ds_read2_b32 v[88:89], v11 offset0:112 offset1:113
    ds_read2_b32 v[90:91], v11 offset0:114 offset1:115
    ds_read_b128 v[96:99], v12 offset:0
    s_waitcnt lgkmcnt(15)
    v_mfma_f32_16x16x32_bf16 v[44:47], v[64:67], v[120:123], v[44:47]
    v_mfma_f32_16x16x32_bf16 v[36:39], v[64:67], v[104:107], v[36:39]
    buffer_load_dwordx4 v[240:243], v1, s[16:19], s49 offen offset:0 sc1
    s_waitcnt lgkmcnt(13)
    v_mfma_f32_16x16x32_bf16 v[40:43], v[76:79], v[104:107], v[40:43]
    v_mfma_f32_16x16x32_bf16 v[44:47], v[80:83], v[104:107], v[44:47]
    s_waitcnt lgkmcnt(12)
    v_mfma_f32_16x16x32_bf16 v[40:43], v[64:67], v[116:119], v[40:43]
    s_waitcnt lgkmcnt(11)
    v_mfma_f32_16x16x32_bf16 v[32:35], v[64:67], v[100:103], v[32:35]
    buffer_load_dwordx4 v[244:247], v1, s[16:19], s49 offen offset:1024 sc1
    v_mfma_f32_16x16x32_bf16 v[40:43], v[80:83], v[100:103], v[40:43]
    s_waitcnt lgkmcnt(10)
    v_mfma_f32_16x16x32_bf16 v[44:47], v[76:79], v[108:111], v[44:47]
    s_waitcnt lgkmcnt(8)
    v_mfma_f32_16x16x32_bf16 v[44:47], v[68:71], v[116:119], v[44:47]
    v_mfma_f32_16x16x32_bf16 v[36:39], v[68:71], v[100:103], v[36:39]
    buffer_load_dwordx4 v[248:251], v1, s[16:19], s49 offen offset:2048 sc1
    s_waitcnt lgkmcnt(6)
    v_mfma_f32_16x16x32_bf16 v[44:47], v[84:87], v[100:103], v[44:47]
    s_waitcnt lgkmcnt(3)
    v_mfma_f32_16x16x32_bf16 v[40:43], v[72:75], v[108:111], v[40:43]
    v_mfma_f32_16x16x32_bf16 v[40:43], v[68:71], v[112:115], v[40:43]
    s_waitcnt lgkmcnt(0)
    v_mfma_f32_16x16x32_bf16 v[32:35], v[68:71], v[96:99], v[32:35]
    buffer_load_dwordx4 v[252:255], v1, s[16:19], s49 offen offset:3072 sc1
    s_add_u32 s50, s50, 4096
    s_and_b32 s50, s50, 0x7fff
    s_add_u32 s49, s48, s50
    v_mfma_f32_16x16x32_bf16 v[40:43], v[84:87], v[96:99], v[40:43]
    v_mfma_f32_16x16x32_bf16 v[44:47], v[72:75], v[112:115], v[44:47]
    v_mfma_f32_16x16x32_bf16 v[36:39], v[72:75], v[96:99], v[36:39]
    v_mfma_f32_16x16x32_bf16 v[44:47], v[88:91], v[96:99], v[44:47]
    ds_read_b64 v[64:65], v14 offset:1024
    ds_read_b64 v[66:67], v14 offset:1536
    ds_read_b64 v[68:69], v14 offset:3072
    ds_read_b64 v[70:71], v14 offset:3584
h_conv_epi:
    s_setprio 3
    s_add_u32 s33, s32, 11534336
    s_lshl_b32 s3, s60, 8
    s_and_b32 s68, s42, 1
    s_lshl_b32 s68, s68, 7
    s_add_u32 s3, s3, s68
    s_add_u32 s3, s3, 6422528
    s_waitcnt lgkmcnt(0)
    v_and_b32 v20, s58, v65
    v_lshlrev_b32 v21, 16, v65
    v_and_b32 v22, s58, v64
    v_lshlrev_b32 v23, 16, v64
    v_fmac_f32 v32, s51, v20
    v_fmac_f32 v33, s51, v21
    v_fmac_f32 v34, s51, v22
    v_fmac_f32 v35, s51, v23
    v_cvt_pk_bf16_f32 v72, v32, v33
    v_cvt_pk_bf16_f32 v73, v34, v35
    ds_write_b64 v15, v[72:73] offset:4608
    v_and_b32 v20, s58, v67
    v_lshlrev_b32 v21, 16, v67
    v_and_b32 v22, s58, v66
    v_lshlrev_b32 v23, 16, v66
    v_fmac_f32 v36, s51, v20
    v_fmac_f32 v37, s51, v21
    v_fmac_f32 v38, s51, v22
    v_fmac_f32 v39, s51, v23
    v_cvt_pk_bf16_f32 v74, v36, v37
    v_cvt_pk_bf16_f32 v75, v38, v39
    ds_write_b64 v15, v[74:75] offset:5120
    v_and_b32 v20, s58, v69
    v_lshlrev_b32 v21, 16, v69
    v_and_b32 v22, s58, v68
    v_lshlrev_b32 v23, 16, v68
    v_fmac_f32 v40, s51, v20
    v_fmac_f32 v41, s51, v21
    v_fmac_f32 v42, s51, v22
    v_fmac_f32 v43, s51, v23
    v_cvt_pk_bf16_f32 v76, v40, v41
    v_cvt_pk_bf16_f32 v77, v42, v43
    ds_write_b64 v15, v[76:77] offset:5632
    v_and_b32 v20, s58, v71
    v_lshlrev_b32 v21, 16, v71
    v_and_b32 v22, s58, v70
    v_lshlrev_b32 v23, 16, v70
    v_fmac_f32 v44, s51, v20
    v_fmac_f32 v45, s51, v21
    v_fmac_f32 v46, s51, v22
    v_fmac_f32 v47, s51, v23
    v_cvt_pk_bf16_f32 v78, v44, v45
    v_cvt_pk_bf16_f32 v79, v46, v47
    ds_write_b64 v15, v[78:79] offset:6144
    ds_read_b128 v[80:83], v7 offset:4608
    ds_read_b128 v[84:87], v7 offset:5632
    s_waitcnt lgkmcnt(0)
    buffer_store_dwordx4 v[80:83], v28, s[16:19], s33 offen sc1
    buffer_store_dwordx4 v[84:87], v28, s[16:19], s33 offen offset:2048 sc1
    s_waitcnt vmcnt(0)
    s_mov_b64 exec, 1
    buffer_store_dword v24, v19, s[16:19], s3 offen sc1
    s_mov_b64 exec, -1
    s_branch h_prep
h_noconv:
    buffer_load_dwordx4 v[128:131], v1, s[16:19], s49 offen offset:0 sc1
    s_waitcnt vmcnt(1)
    buffer_load_dwordx4 v[132:135], v1, s[16:19], s49 offen offset:1024 sc1
    s_waitcnt vmcnt(1)
    buffer_load_dwordx4 v[136:139], v1, s[16:19], s49 offen offset:2048 sc1
    s_waitcnt vmcnt(1)
    buffer_load_dwordx4 v[140:143], v1, s[16:19], s49 offen offset:3072 sc1
    s_add_u32 s50, s50, 4096
    s_and_b32 s50, s50, 0x7fff
    s_add_u32 s49, s48, s50
    s_waitcnt vmcnt(1)
    buffer_load_dwordx4 v[144:147], v1, s[16:19], s49 offen offset:0 sc1
    s_waitcnt vmcnt(1)
    buffer_load_dwordx4 v[148:151], v1, s[16:19], s49 offen offset:1024 sc1
    s_waitcnt vmcnt(1)
    buffer_load_dwordx4 v[152:155], v1, s[16:19], s49 offen offset:2048 sc1
    s_waitcnt vmcnt(1)
    buffer_load_dwordx4 v[156:159], v1, s[16:19], s49 offen offset:3072 sc1
    s_add_u32 s50, s50, 4096
    s_and_b32 s50, s50, 0x7fff
    s_add_u32 s49, s48, s50
    s_waitcnt vmcnt(1)
    buffer_load_dwordx4 v[160:163], v1, s[16:19], s49 offen offset:0 sc1
    s_waitcnt vmcnt(1)
    buffer_load_dwordx4 v[164:167], v1, s[16:19], s49 offen offset:1024 sc1
    s_waitcnt vmcnt(1)
    buffer_load_dwordx4 v[168:171], v1, s[16:19], s49 offen offset:2048 sc1
    s_waitcnt vmcnt(1)
    buffer_load_dwordx4 v[172:175], v1, s[16:19], s49 offen offset:3072 sc1
    s_add_u32 s50, s50, 4096
    s_and_b32 s50, s50, 0x7fff
    s_add_u32 s49, s48, s50
    s_waitcnt vmcnt(1)
    buffer_load_dwordx4 v[176:179], v1, s[16:19], s49 offen offset:0 sc1
    s_waitcnt vmcnt(1)
    buffer_load_dwordx4 v[180:183], v1, s[16:19], s49 offen offset:1024 sc1
    s_waitcnt vmcnt(1)
    buffer_load_dwordx4 v[184:187], v1, s[16:19], s49 offen offset:2048 sc1
    s_waitcnt vmcnt(1)
    buffer_load_dwordx4 v[188:191], v1, s[16:19], s49 offen offset:3072 sc1
    s_add_u32 s50, s50, 4096
    s_and_b32 s50, s50, 0x7fff
    s_add_u32 s49, s48, s50
    s_waitcnt vmcnt(1)
    buffer_load_dwordx4 v[192:195], v1, s[16:19], s49 offen offset:0 sc1
    s_waitcnt vmcnt(1)
    buffer_load_dwordx4 v[196:199], v1, s[16:19], s49 offen offset:1024 sc1
    s_waitcnt vmcnt(1)
    buffer_load_dwordx4 v[200:203], v1, s[16:19], s49 offen offset:2048 sc1
    s_waitcnt vmcnt(1)
    buffer_load_dwordx4 v[204:207], v1, s[16:19], s49 offen offset:3072 sc1
    s_add_u32 s50, s50, 4096
    s_and_b32 s50, s50, 0x7fff
    s_add_u32 s49, s48, s50
    s_waitcnt vmcnt(1)
    buffer_load_dwordx4 v[208:211], v1, s[16:19], s49 offen offset:0 sc1
    s_waitcnt vmcnt(1)
    buffer_load_dwordx4 v[212:215], v1, s[16:19], s49 offen offset:1024 sc1
    s_waitcnt vmcnt(1)
    buffer_load_dwordx4 v[216:219], v1, s[16:19], s49 offen offset:2048 sc1
    s_waitcnt vmcnt(1)
    buffer_load_dwordx4 v[220:223], v1, s[16:19], s49 offen offset:3072 sc1
    s_add_u32 s50, s50, 4096
    s_and_b32 s50, s50, 0x7fff
    s_add_u32 s49, s48, s50
    s_waitcnt vmcnt(1)
    buffer_load_dwordx4 v[224:227], v1, s[16:19], s49 offen offset:0 sc1
    s_waitcnt vmcnt(1)
    buffer_load_dwordx4 v[228:231], v1, s[16:19], s49 offen offset:1024 sc1
    s_waitcnt vmcnt(1)
    buffer_load_dwordx4 v[232:235], v1, s[16:19], s49 offen offset:2048 sc1
    s_waitcnt vmcnt(1)
    buffer_load_dwordx4 v[236:239], v1, s[16:19], s49 offen offset:3072 sc1
    s_add_u32 s50, s50, 4096
    s_and_b32 s50, s50, 0x7fff
    s_add_u32 s49, s48, s50
    s_waitcnt vmcnt(1)
    buffer_load_dwordx4 v[240:243], v1, s[16:19], s49 offen offset:0 sc1
    s_waitcnt vmcnt(1)
    buffer_load_dwordx4 v[244:247], v1, s[16:19], s49 offen offset:1024 sc1
    s_waitcnt vmcnt(1)
    buffer_load_dwordx4 v[248:251], v1, s[16:19], s49 offen offset:2048 sc1
    s_waitcnt vmcnt(1)
    buffer_load_dwordx4 v[252:255], v1, s[16:19], s49 offen offset:3072 sc1
    s_add_u32 s50, s50, 4096
    s_and_b32 s50, s50, 0x7fff
    s_add_u32 s49, s48, s50
    s_waitcnt vmcnt(1)
    s_cmp_lg_u32 s59, 1021
    s_cbranch_scc1 h_prep
    v_lshlrev_b32 v23, 9, v0
    s_mov_b32 s3, 6324224
h_gwait:
    buffer_load_dword v64, v23, s[16:19], s3 offen sc1
    buffer_load_dword v65, v23, s[16:19], s3 offen offset:128 sc1
    buffer_load_dword v66, v23, s[16:19], s3 offen offset:256 sc1
    buffer_load_dword v67, v23, s[16:19], s3 offen offset:384 sc1
    s_sub_u32 s34, s34, 1
    s_waitcnt vmcnt(0)
    v_min3_u32 v68, v64, v65, v66
    v_max3_u32 v69, v64, v65, v66
    v_min3_u32 v68, v68, v67, v24
    v_max3_u32 v69, v69, v67, v24
    v_cmp_ne_u32 vcc, v68, v69
    s_cbranch_scc1 h_gdone
    s_and_b64 exec, exec, vcc
    s_cbranch_execnz h_gwait
h_gdone:
    s_mov_b32 s3, 6225920
    s_mov_b64 exec, 1
    buffer_store_dword v24, v19, s[16:19], s3 offen sc1
    s_mov_b64 exec, -1
h_prep:
    s_lshl_b32 s32, s61, 15
    s_lshl_b32 s3, s42, 13
    s_add_u32 s32, s32, s3
    s_add_u32 s32, s32, 8388608
    s_add_u32 s33, s32, 4096
    s_add_u32 s3, s3, 0
    v_add_u32 v7, s3, v1
    s_mov_b32 s35, 0xffff
    s_mul_i32 s47, s62, 114688
    s_lshl_b32 s3, s61, 6
    s_add_u32 s47, s47, s3
    s_add_u32 s47, s47, 11534336
    s_add_u32 s48, s47, 64512
    s_add_u32 m0, s63, 15104
    s_mov_b32 s34, 200000
    s_add_u32 s3, s42, 1
    s_and_b32 s3, s3, 3
    s_lshl_b32 s3, s3, 13
    s_add_u32 s3, s3, 0
    v_add_u32 v16, s3, v1
    s_add_u32 s3, s42, 2
    s_and_b32 s3, s3, 3
    s_lshl_b32 s3, s3, 13
    s_add_u32 s3, s3, 0
    v_add_u32 v17, s3, v1
    s_add_u32 s3, s42, 3
    s_and_b32 s3, s3, 3
    s_lshl_b32 s3, s3, 13
    s_add_u32 s3, s3, 0
    v_add_u32 v18, s3, v1
    s_setprio 0
    s_mov_b32 s68, 200000
h_ewait:
    ds_read_b32 v22, v25 offset:52
    s_sub_u32 s68, s68, 1
    s_waitcnt lgkmcnt(0)
    v_cmp_gt_u32 vcc, 4, v22
    s_cbranch_scc1 h_ewait_ok
    s_cbranch_vccz h_ewait_ok
    s_sleep 2
    s_branch h_ewait
h_ewait_ok:
h_oprobe:
    buffer_load_dword v8, v31, s[16:19], s32 offen offset:2044 sc1
    s_sub_u32 s34, s34, 1
    s_waitcnt vmcnt(0)
    v_cmp_gt_u32 vcc, s58, v8
    s_cbranch_scc1 h_oready
    s_cbranch_vccnz h_oprobe
h_opoll:
    buffer_load_dword v9, v13, s[16:19], s57 offen sc1
    buffer_load_dwordx4 v[64:67], v1, s[16:19], s32 offen offset:0 sc1
    buffer_load_dwordx4 v[68:71], v1, s[16:19], s32 offen offset:1024 sc1
    buffer_load_dwordx4 v[72:75], v1, s[16:19], s32 offen offset:2048 sc1
    buffer_load_dwordx4 v[76:79], v1, s[16:19], s32 offen offset:3072 sc1
    buffer_load_dwordx4 v[80:83], v1, s[16:19], s33 offen offset:0 sc1
    buffer_load_dwordx4 v[84:87], v1, s[16:19], s33 offen offset:1024 sc1
    buffer_load_dwordx4 v[88:91], v1, s[16:19], s33 offen offset:2048 sc1
    buffer_load_dwordx4 v[92:95], v1, s[16:19], s33 offen offset:3072 sc1
    s_waitcnt vmcnt(8)
    v_cmp_ne_u32 s[36:37], v9, v24
    s_nop 3
    s_cmp_lg_u64 s[36:37], 0
    s_cbranch_scc1 h_zlater
    buffer_load_dwordx4 v27, s[16:19], s47 offen sc1 lds
    s_mov_b32 exec_hi, 0xffff
    buffer_load_dwordx4 v27, s[16:19], s48 offen offset:1024 sc1 lds
    s_mov_b32 exec_hi, -1
    s_waitcnt vmcnt(2)
    s_branch h_ocheck
h_zlater:
    s_waitcnt vmcnt(0)
h_ocheck:
    s_sub_u32 s34, s34, 1
    v_min3_u32 v8, v67, v71, v75
    v_min3_u32 v10, v79, v83, v87
    v_min3_u32 v8, v8, v91, v95
    v_min_u32 v8, v8, v10
    v_cmp_gt_u32 vcc, s58, v8
    s_cbranch_scc1 h_oready
    s_cbranch_vccnz h_oprobe
h_oready:
    v_and_b32 v67, s35, v67
    ds_write_b128 v7, v[64:67] offset:0
    v_and_b32 v71, s35, v71
    ds_write_b128 v7, v[68:71] offset:1024
    v_and_b32 v75, s35, v75
    ds_write_b128 v7, v[72:75] offset:2048
    v_and_b32 v79, s35, v79
    ds_write_b128 v7, v[76:79] offset:3072
    v_and_b32 v83, s35, v83
    ds_write_b128 v7, v[80:83] offset:4096
    v_and_b32 v87, s35, v87
    ds_write_b128 v7, v[84:87] offset:5120
    v_and_b32 v91, s35, v91
    ds_write_b128 v7, v[88:91] offset:6144
    v_and_b32 v95, s35, v95
    ds_write_b128 v7, v[92:95] offset:7168
    v_mfma_f32_32x32x16_bf16 v[32:47], v[64:67], v[128:131], 0
    v_mfma_f32_32x32x16_bf16 v[32:47], v[68:71], v[132:135], v[32:47]
    v_mfma_f32_32x32x16_bf16 v[32:47], v[72:75], v[136:139], v[32:47]
    v_mfma_f32_32x32x16_bf16 v[32:47], v[76:79], v[140:143], v[32:47]
    s_waitcnt lgkmcnt(0)
    s_barrier
    ds_read_b128 v[96:99], v16 offset:0
    ds_read_b128 v[100:103], v16 offset:1024
    ds_read_b128 v[104:107], v16 offset:2048
    ds_read_b128 v[108:111], v16 offset:3072
    ds_read_b128 v[112:115], v16 offset:4096
    ds_read_b128 v[116:119], v16 offset:5120
    ds_read_b128 v[120:123], v16 offset:6144
    ds_read_b128 v[124:127], v16 offset:7168
    ds_read_b128 v[64:67], v17 offset:0
    ds_read_b128 v[68:71], v17 offset:1024
    ds_read_b128 v[72:75], v17 offset:2048
    ds_read_b128 v[76:79], v17 offset:3072
    v_mfma_f32_32x32x16_bf16 v[32:47], v[80:83], v[144:147], v[32:47]
    v_mfma_f32_32x32x16_bf16 v[32:47], v[84:87], v[148:151], v[32:47]
    v_mfma_f32_32x32x16_bf16 v[32:47], v[88:91], v[152:155], v[32:47]
    v_mfma_f32_32x32x16_bf16 v[32:47], v[92:95], v[156:159], v[32:47]
    s_waitcnt lgkmcnt(11)
    v_mfma_f32_32x32x16_bf16 v[32:47], v[96:99], v[160:163], v[32:47]
    ds_read_b128 v[96:99], v17 offset:4096
    s_waitcnt lgkmcnt(11)
    v_mfma_f32_32x32x16_bf16 v[32:47], v[100:103], v[164:167], v[32:47]
    ds_read_b128 v[100:103], v17 offset:5120
    s_waitcnt lgkmcnt(11)
    v_mfma_f32_32x32x16_bf16 v[32:47], v[104:107], v[168:171], v[32:47]
    ds_read_b128 v[104:107], v17 offset:6144
    s_waitcnt lgkmcnt(11)
    v_mfma_f32_32x32x16_bf16 v[32:47], v[108:111], v[172:175], v[32:47]
    ds_read_b128 v[108:111], v17 offset:7168
    s_waitcnt lgkmcnt(11)
    v_mfma_f32_32x32x16_bf16 v[32:47], v[112:115], v[176:179], v[32:47]
    ds_read_b128 v[112:115], v18 offset:0
    s_waitcnt lgkmcnt(11)
    v_mfma_f32_32x32x16_bf16 v[32:47], v[116:119], v[180:183], v[32:47]
    ds_read_b128 v[116:119], v18 offset:1024
    s_waitcnt lgkmcnt(11)
    v_mfma_f32_32x32x16_bf16 v[32:47], v[120:123], v[184:187], v[32:47]
    ds_read_b128 v[120:123], v18 offset:2048
    s_waitcnt lgkmcnt(11)
    v_mfma_f32_32x32x16_bf16 v[32:47], v[124:127], v[188:191], v[32:47]
    ds_read_b128 v[124:127], v18 offset:3072
    s_waitcnt lgkmcnt(11)
    v_mfma_f32_32x32x16_bf16 v[32:47], v[64:67], v[192:195], v[32:47]
    ds_read_b128 v[64:67], v18 offset:4096
    s_waitcnt lgkmcnt(11)
    v_mfma_f32_32x32x16_bf16 v[32:47], v[68:71], v[196:199], v[32:47]
    ds_read_b128 v[68:71], v18 offset:5120
    s_waitcnt lgkmcnt(11)
    v_mfma_f32_32x32x16_bf16 v[32:47], v[72:75], v[200:203], v[32:47]
    ds_read_b128 v[72:75], v18 offset:6144
    s_waitcnt lgkmcnt(11)
    v_mfma_f32_32x32x16_bf16 v[32:47], v[76:79], v[204:207], v[32:47]
    ds_read_b128 v[76:79], v18 offset:7168
    s_waitcnt lgkmcnt(11)
    v_mfma_f32_32x32x16_bf16 v[32:47], v[96:99], v[208:211], v[32:47]
    s_waitcnt lgkmcnt(10)
    v_mfma_f32_32x32x16_bf16 v[32:47], v[100:103], v[212:215], v[32:47]
    s_waitcnt lgkmcnt(9)
    v_mfma_f32_32x32x16_bf16 v[32:47], v[104:107], v[216:219], v[32:47]
    s_waitcnt lgkmcnt(8)
    v_mfma_f32_32x32x16_bf16 v[32:47], v[108:111], v[220:223], v[32:47]
    s_waitcnt lgkmcnt(7)
    v_mfma_f32_32x32x16_bf16 v[32:47], v[112:115], v[224:227], v[32:47]
    s_waitcnt lgkmcnt(6)
    v_mfma_f32_32x32x16_bf16 v[32:47], v[116:119], v[228:231], v[32:47]
    s_waitcnt lgkmcnt(5)
    v_mfma_f32_32x32x16_bf16 v[32:47], v[120:123], v[232:235], v[32:47]
    s_waitcnt lgkmcnt(4)
    v_mfma_f32_32x32x16_bf16 v[32:47], v[124:127], v[236:239], v[32:47]
    s_waitcnt lgkmcnt(3)
    v_mfma_f32_32x32x16_bf16 v[32:47], v[64:67], v[240:243], v[32:47]
    s_waitcnt lgkmcnt(2)
    v_mfma_f32_32x32x16_bf16 v[32:47], v[68:71], v[244:247], v[32:47]
    s_waitcnt lgkmcnt(1)
    v_mfma_f32_32x32x16_bf16 v[32:47], v[72:75], v[248:251], v[32:47]
    s_waitcnt lgkmcnt(0)
    v_mfma_f32_32x32x16_bf16 v[32:47], v[76:79], v[252:255], v[32:47]
    s_cmp_eq_u64 s[36:37], 0
    s_cbranch_scc1 h_zready
    s_mov_b32 s68, 200000
    s_mov_b32 exec_hi, 0
h_zpoll:
    buffer_load_dword v22, v13, s[16:19], s57 offen sc1
    s_sub_u32 s68, s68, 1
    s_waitcnt vmcnt(0)
    v_cmp_ne_u32 vcc, v22, v24
    s_cbranch_scc1 h_zpoll_ok
    s_and_b64 exec, exec, vcc
    s_cbranch_execz h_zpoll_ok
    s_sleep 1
    s_branch h_zpoll
h_zpoll_ok:
    s_mov_b64 exec, -1
    buffer_load_dwordx4 v27, s[16:19], s47 offen sc1 lds
    s_mov_b32 exec_hi, 0xffff
    buffer_load_dwordx4 v27, s[16:19], s48 offen offset:1024 sc1 lds
    s_mov_b32 exec_hi, -1
h_zready:
    s_waitcnt vmcnt(0)
    ds_read_b64 v[80:81], v30 offset:15104
    ds_read_b64 v[82:83], v30 offset:15120
    ds_read_b64 v[84:85], v30 offset:15136
    ds_read_b64 v[86:87], v30 offset:15152
    s_waitcnt lgkmcnt(0)
    s_nop 4
    v_lshlrev_b32 v22, 16, v80
    v_and_b32 v23, s58, v80
    v_pk_fma_f32 v[32:33], v[48:49], v[22:23], v[32:33]
    v_cvt_pk_bf16_f32 v88, v32, v33
    buffer_store_short v88, v4, s[12:15], s53 offen offset:0
    buffer_store_short_d16_hi v88, v4, s[12:15], s53 offen offset:896
    v_lshlrev_b32 v22, 16, v81
    v_and_b32 v23, s58, v81
    v_pk_fma_f32 v[34:35], v[50:51], v[22:23], v[34:35]
    v_cvt_pk_bf16_f32 v89, v34, v35
    buffer_store_short v89, v4, s[12:15], s53 offen offset:1792
    buffer_store_short_d16_hi v89, v4, s[12:15], s53 offen offset:2688
    v_lshlrev_b32 v22, 16, v82
    v_and_b32 v23, s58, v82
    v_pk_fma_f32 v[36:37], v[52:53], v[22:23], v[36:37]
    v_cvt_pk_bf16_f32 v90, v36, v37
    buffer_store_short v90, v4, s[12:15], s54 offen offset:0
    buffer_store_short_d16_hi v90, v4, s[12:15], s54 offen offset:896
    v_lshlrev_b32 v22, 16, v83
    v_and_b32 v23, s58, v83
    v_pk_fma_f32 v[38:39], v[54:55], v[22:23], v[38:39]
    v_cvt_pk_bf16_f32 v91, v38, v39
    buffer_store_short v91, v4, s[12:15], s54 offen offset:1792
    buffer_store_short_d16_hi v91, v4, s[12:15], s54 offen offset:2688
    v_lshlrev_b32 v22, 16, v84
    v_and_b32 v23, s58, v84
    v_pk_fma_f32 v[40:41], v[56:57], v[22:23], v[40:41]
    v_cvt_pk_bf16_f32 v92, v40, v41
    buffer_store_short v92, v4, s[12:15], s55 offen offset:0
    buffer_store_short_d16_hi v92, v4, s[12:15], s55 offen offset:896
    v_lshlrev_b32 v22, 16, v85
    v_and_b32 v23, s58, v85
    v_pk_fma_f32 v[42:43], v[58:59], v[22:23], v[42:43]
    v_cvt_pk_bf16_f32 v93, v42, v43
    buffer_store_short v93, v4, s[12:15], s55 offen offset:1792
    buffer_store_short_d16_hi v93, v4, s[12:15], s55 offen offset:2688
    v_lshlrev_b32 v22, 16, v86
    v_and_b32 v23, s58, v86
    v_pk_fma_f32 v[44:45], v[60:61], v[22:23], v[44:45]
    v_cvt_pk_bf16_f32 v94, v44, v45
    buffer_store_short v94, v4, s[12:15], s56 offen offset:0
    buffer_store_short_d16_hi v94, v4, s[12:15], s56 offen offset:896
    v_lshlrev_b32 v22, 16, v87
    v_and_b32 v23, s58, v87
    v_pk_fma_f32 v[46:47], v[62:63], v[22:23], v[46:47]
    v_cvt_pk_bf16_f32 v95, v46, v47
    buffer_store_short v95, v4, s[12:15], s56 offen offset:1792
    buffer_store_short_d16_hi v95, v4, s[12:15], s56 offen offset:2688
    s_endpgm
m_start:
    s_waitcnt lgkmcnt(0)
    s_add_u32 s28, s28, 0
    s_addc_u32 s29, s29, 0
    s_add_u32 s30, s28, 6225920
    s_addc_u32 s31, s29, 0
    s_load_dword s65, s[30:31], 0
    s_mov_b32 s16, s28
    s_mov_b32 s17, s29
    s_mov_b32 s18, 16777216
    s_mov_b32 s19, 0x00020000
    v_lshrrev_b32 v21, 5, v0
    v_and_b32 v20, 31, v0
    v_bfe_u32 v22, v0, 1, 3
    v_lshlrev_b32 v23, 7, v20
    s_lshl_b32 s3, s42, 12
    v_add_u32 v23, s3, v23
    v_xor_b32 v24, v21, v22
    v_xor_b32 v25, 0, v24
    v_lshl_add_u32 v2, v25, 4, v23
    v_add_u32 v6, 49152, v2
    v_xor_b32 v25, 2, v24
    v_lshl_add_u32 v3, v25, 4, v23
    v_add_u32 v7, 49152, v3
    v_xor_b32 v25, 4, v24
    v_lshl_add_u32 v4, v25, 4, v23
    v_add_u32 v8, 49152, v4
    v_xor_b32 v25, 6, v24
    v_lshl_add_u32 v5, v25, 4, v23
    v_add_u32 v9, 49152, v5
    v_bfe_u32 v22, v0, 2, 2
    v_lshl_add_u32 v22, v21, 3, v22
    v_bfe_u32 v23, v0, 4, 1
    v_lshlrev_b32 v23, 5, v23
    v_and_b32 v24, 3, v0
    v_lshl_add_u32 v23, v24, 3, v23
    v_lshl_add_u32 v14, v22, 6, v23
    v_add_u32 v14, 98304, v14
    v_lshl_add_u32 v22, v22, 7, v23
    v_bfe_u32 v24, v0, 3, 1
    v_lshl_add_u32 v22, v24, 6, v22
    v_add_u32 v10, 16384, v22
    v_xor_b32 v11, 64, v10
    v_add_u32 v12, 49152, v10
    v_add_u32 v13, 49152, v11
    v_mov_b32 v22, 0
    v_and_b32 v23, 31, v0
    v_lshlrev_b32 v23, 2, v23
    v_add_u32 v23, 143360, v23
    ds_write_b32 v23, v22
    s_lshl_b32 s36, s41, 2
    s_add_u32 s36, s36, s42
    s_mul_i32 s47, s36, 57344
    s_and_b32 s3, s43, 1
    s_mul_i32 s46, s3, 7
    s_add_u32 s46, s46, s45
    s_lshl_b32 s46, s46, 4
    s_add_u32 s46, s46, s41
    s_lshl_b32 s46, s46, 7
    s_add_u32 s46, s46, 6291456
    s_cmp_eq_u32 s45, 7
    s_cselect_b32 s47, 1073741824, s47
    s_cselect_b32 s46, 1073741824, s46
    s_cmp_ge_u32 s44, 8
    s_cselect_b32 s47, 1073741824, s47
    s_cselect_b32 s46, 1073741824, s46
    s_lshl_b32 s3, s42, 12
    s_add_u32 s3, s3, 144000
    v_lshl_add_u32 v17, v0, 4, s3
    s_waitcnt lgkmcnt(0)
    s_mul_i32 s65, s65, 0x9e3779b1
    s_add_u32 s65, s65, 0x7f4a7c15
    s_mov_b32 s20, s24
    s_mov_b32 s21, s25
    s_mov_b32 s22, 1204224
    s_mov_b32 s23, 0x00020000
    v_lshlrev_b32 v1, 4, v0
    s_mul_i32 s30, s42, 917504
    s_mul_i32 s3, s40, 7
    s_add_u32 s3, s3, 1
    s_lshr_b32 s3, s3, 1
    s_lshl_b32 s3, s3, 9
    v_add_u32 v152, s3, v1
    v_add_u32 v153, 1024, v152
    s_and_b32 s3, s40, 1
    s_mov_b32 exec_lo, 0
    s_sub_u32 exec_hi, 0, s3
    v_subrev_u32 v153, 1016, v152
    s_mov_b64 exec, -1
    s_mul_i32 s3, s40, 28
    v_cmp_lt_u32 vcc, 11, v20
    v_cmp_lt_u32 s[50:51], 15, v20
    v_cmp_lt_u32 s[52:53], 27, v20
    v_add_u32 v22, s3, v20
    v_subb_co_u32 v22, vcc, v22, 0, vcc
    v_subb_co_u32 v22, vcc, v22, 0, s[50:51]
    v_subb_co_u32 v22, vcc, v22, 0, s[52:53]
    v_mul_u32_u24 v23, 7168, v21
    v_lshl_add_u32 v22, v22, 4, v23
    v_add_u32 v154, 28672, v22
    v_add_u32 v155, 43008, v22
    v_bfe_u32 v22, v0, 4, 1
    v_mul_u32_u24 v22, 27, v22
    v_add_u32 v22, s3, v22
    v_lshrrev_b32 v22, 6, v22
    v_mad_u32_u24 v22, v21, 7, v22
    v_lshlrev_b32 v22, 11, v22
    v_bfe_u32 v23, v0, 2, 2
    v_lshl_add_u32 v159, v23, 7, v22
    s_lshl_b32 s35, s42, 9
    s_add_u32 s35, s35, 6291456
    s_mov_b32 s48, 0
    s_mov_b32 s49, -1
    s_mov_b32 s50, 0x77ff77ff
    s_mov_b32 s51, 0x77ff77ff
    v_mov_b32 v156, 0x3f803f80
    v_mov_b32 v157, 143360
    v_mov_b32 v158, 1
    v_mov_b32 v24, s65
    v_mov_b32 v25, 0
    s_lshl_b32 s3, s42, 7
    s_add_u32 s3, s3, 143488
    v_lshl_add_u32 v26, v20, 2, s3
    s_lshl_b32 s39, s36, 15
    s_lshl_b32 s3, s40, 11
    s_add_u32 s39, s39, s3
    s_add_u32 s39, s39, 8388608
    s_add_u32 s54, s30, 57344
    s_add_u32 s55, s30, 114688
    s_add_u32 s31, s30, 172032
    s_mov_b32 s38, 0x5f800000
    s_add_u32 s3, s42, 0
    s_and_b32 s3, s3, 3
    s_lshl_b32 s56, s3, 11
    s_add_u32 s56, s56, 126976
    s_mul_i32 s60, s3, 12288
    s_add_u32 s60, s60, 0
    s_add_u32 s3, s42, 1
    s_and_b32 s3, s3, 3
    s_lshl_b32 s57, s3, 11
    s_add_u32 s57, s57, 126976
    s_mul_i32 s61, s3, 12288
    s_add_u32 s61, s61, 0
    s_add_u32 s3, s42, 2
    s_and_b32 s3, s3, 3
    s_lshl_b32 s58, s3, 11
    s_add_u32 s58, s58, 126976
    s_mul_i32 s62, s3, 12288
    s_add_u32 s62, s62, 4096
    s_add_u32 s3, s42, 3
    s_and_b32 s3, s3, 3
    s_lshl_b32 s59, s3, 11
    s_add_u32 s59, s59, 126976
    s_mul_i32 s63, s3, 12288
    s_add_u32 s63, s63, 8192
    v_pk_mov_b32 v[168:169], v[156:157], v[156:157] op_sel:[0,0]
    v_pk_mov_b32 v[170:171], v[156:157], v[156:157] op_sel:[0,0]
    v_pk_mov_b32 v[172:173], v[156:157], v[156:157] op_sel:[0,0]
    v_pk_mov_b32 v[174:175], v[156:157], v[156:157] op_sel:[0,0]
    v_pk_mov_b32 v[184:185], v[156:157], v[156:157] op_sel:[0,0]
    v_pk_mov_b32 v[186:187], v[156:157], v[156:157] op_sel:[0,0]
    v_pk_mov_b32 v[188:189], v[156:157], v[156:157] op_sel:[0,0]
    v_pk_mov_b32 v[190:191], v[156:157], v[156:157] op_sel:[0,0]
    v_pk_mov_b32 v[200:201], v[156:157], v[156:157] op_sel:[0,0]
    v_pk_mov_b32 v[202:203], v[156:157], v[156:157] op_sel:[0,0]
    v_pk_mov_b32 v[204:205], v[156:157], v[156:157] op_sel:[0,0]
    v_pk_mov_b32 v[206:207], v[156:157], v[156:157] op_sel:[0,0]
    v_mov_b32 v28, 0
    v_mov_b32 v29, 0
    v_mov_b32 v30, 0
    v_mov_b32 v31, 0
    s_getpc_b64 s[4:5]
m_pc:
    s_sub_u32 s4, s4, m_pc-gated_mix__ssm_conv_h3__mha_block__prompt_kernel
    s_subb_u32 s5, s5, 0
    s_lshl_b32 s3, s44, 2
    s_add_u32 s3, s3, s42
    s_mul_i32 s3, s3, 384
    v_lshl_add_u32 v22, v0, 7, s3
    v_cmp_gt_u32 vcc, all_end-gated_mix__ssm_conv_h3__mha_block__prompt_kernel, v22
    s_and_b64 exec, vcc, 7
    s_cbranch_execz m_nopf
    global_load_dword v27, v22, s[4:5]
m_nopf:
    s_mov_b64 exec, -1
    s_cmp_lg_u32 s42, 0
    s_cbranch_scc1 m_notidle
    s_and_b32 s3, s43, 1
    s_mul_i32 s3, s3, 384
    s_mul_i32 s53, s44, 37632
    s_add_u32 s3, s3, s53
    v_lshrrev_b32 v22, 2, v0
    v_mul_u32_u24 v22, 0xa80, v22
    v_and_b32 v23, 3, v0
    v_lshl_add_u32 v22, v23, 7, v22
    s_mov_b32 exec_hi, 0xffffff
    buffer_load_dword v27, v22, s[20:23], s3 offen
    s_mov_b32 exec_hi, -1
m_notidle:
    s_cmp_lg_u32 s45, 7
    s_cbranch_scc1 m_nor7h
    s_load_dwordx2 s[8:9], s[0:1], 32
    s_and_b32 s3, s43, 1
    s_lshl_b32 s3, s3, 4
    s_add_u32 s3, s3, s41
    s_lshl_b32 s3, s3, 2
    s_add_u32 s3, s3, s42
    s_mul_i32 s3, s3, 14336
    s_add_u32 s53, s3, 7168
    v_lshlrev_b32 v22, 7, v0
    s_mov_b32 s10, 1835008
    s_mov_b32 s11, 0x00020000
    s_mov_b32 exec_hi, 0xffffff
    s_waitcnt lgkmcnt(0)
    s_waitcnt vmcnt(0)
    buffer_load_dword v27, v22, s[8:11], s3 offen
    buffer_load_dword v27, v22, s[8:11], s53 offen
    s_mov_b32 exec_hi, -1
m_nor7h:
    s_bitcmp1_b32 s43, 0
    s_cbranch_scc1 m_vtype
    s_lshl_b32 s3, s45, 12
    v_lshl_add_u32 v15, v0, 4, s3
    s_barrier
    ds_read_b128 v[32:35], v2 offset:0
    ds_read_b64_tr_b16 v[144:145], v10 offset:0
    ds_read_b64_tr_b16 v[146:147], v10 offset:512
    ds_read_b64_tr_b16 v[148:149], v11 offset:0
    ds_read_b64_tr_b16 v[150:151], v11 offset:512
    ds_read_b128 v[36:39], v3 offset:0
    ds_read_b64_tr_b16 v[240:241], v10 offset:2048
    ds_read_b64_tr_b16 v[242:243], v10 offset:2560
    ds_read_b64_tr_b16 v[244:245], v11 offset:2048
    ds_read_b64_tr_b16 v[246:247], v11 offset:2560
    s_waitcnt lgkmcnt(5)
    v_mfma_f32_32x32x16_bf16 v[208:223], v[144:147], v[32:35], 0
    ds_read_b128 v[40:43], v4 offset:0
    ds_read_b64_tr_b16 v[248:249], v10 offset:4096
    ds_read_b64_tr_b16 v[250:251], v10 offset:4608
    v_mfma_f32_32x32x16_bf16 v[224:239], v[148:151], v[32:35], 0
    ds_read_b64_tr_b16 v[252:253], v11 offset:4096
    ds_read_b64_tr_b16 v[254:255], v11 offset:4608
    s_waitcnt lgkmcnt(5)
    v_mfma_f32_32x32x16_bf16 v[208:223], v[240:243], v[36:39], v[208:223]
    ds_read_b128 v[44:47], v5 offset:0
    ds_read_b64_tr_b16 v[144:145], v10 offset:6144
    ds_read_b64_tr_b16 v[146:147], v10 offset:6656
    v_mfma_f32_32x32x16_bf16 v[224:239], v[244:247], v[36:39], v[224:239]
    ds_read_b64_tr_b16 v[148:149], v11 offset:6144
    ds_read_b64_tr_b16 v[150:151], v11 offset:6656
    s_waitcnt lgkmcnt(5)
    v_mfma_f32_32x32x16_bf16 v[208:223], v[248:251], v[40:43], v[208:223]
    v_mfma_f32_32x32x16_bf16 v[224:239], v[252:255], v[40:43], v[224:239]
    s_barrier
    ds_read_b128 v[48:51], v2 offset:24576
    ds_read_b64_tr_b16 v[240:241], v10 offset:24576
    ds_read_b64_tr_b16 v[242:243], v10 offset:25088
    ds_read_b64_tr_b16 v[244:245], v11 offset:24576
    ds_read_b64_tr_b16 v[246:247], v11 offset:25088
    s_waitcnt lgkmcnt(5)
    v_mfma_f32_32x32x16_bf16 v[208:223], v[144:147], v[44:47], v[208:223]
    ds_read_b128 v[52:55], v3 offset:24576
    ds_read_b64_tr_b16 v[248:249], v10 offset:26624
    ds_read_b64_tr_b16 v[250:251], v10 offset:27136
    v_mfma_f32_32x32x16_bf16 v[224:239], v[148:151], v[44:47], v[224:239]
    ds_read_b64_tr_b16 v[252:253], v11 offset:26624
    ds_read_b64_tr_b16 v[254:255], v11 offset:27136
    s_waitcnt lgkmcnt(5)
    v_mfma_f32_32x32x16_bf16 v[208:223], v[240:243], v[48:51], v[208:223]
    ds_read_b128 v[56:59], v4 offset:24576
    ds_read_b64_tr_b16 v[144:145], v10 offset:28672
    ds_read_b64_tr_b16 v[146:147], v10 offset:29184
    v_mfma_f32_32x32x16_bf16 v[224:239], v[244:247], v[48:51], v[224:239]
    ds_read_b64_tr_b16 v[148:149], v11 offset:28672
    ds_read_b64_tr_b16 v[150:151], v11 offset:29184
    s_waitcnt lgkmcnt(5)
    v_mfma_f32_32x32x16_bf16 v[208:223], v[248:251], v[52:55], v[208:223]
    ds_read_b128 v[60:63], v5 offset:24576
    ds_read_b64_tr_b16 v[240:241], v10 offset:30720
    ds_read_b64_tr_b16 v[242:243], v10 offset:31232
    v_mfma_f32_32x32x16_bf16 v[224:239], v[252:255], v[52:55], v[224:239]
    ds_read_b64_tr_b16 v[244:245], v11 offset:30720
    ds_read_b64_tr_b16 v[246:247], v11 offset:31232
    s_waitcnt lgkmcnt(5)
    v_mfma_f32_32x32x16_bf16 v[208:223], v[144:147], v[56:59], v[208:223]
    v_mfma_f32_32x32x16_bf16 v[224:239], v[148:151], v[56:59], v[224:239]
    s_barrier
    ds_read_b128 v[64:67], v6 offset:0
    ds_read_b64_tr_b16 v[248:249], v12 offset:0
    ds_read_b64_tr_b16 v[250:251], v12 offset:512
    ds_read_b64_tr_b16 v[252:253], v13 offset:0
    ds_read_b64_tr_b16 v[254:255], v13 offset:512
    s_waitcnt lgkmcnt(5)
    v_mfma_f32_32x32x16_bf16 v[208:223], v[240:243], v[60:63], v[208:223]
    ds_read_b128 v[68:71], v7 offset:0
    ds_read_b64_tr_b16 v[144:145], v12 offset:2048
    ds_read_b64_tr_b16 v[146:147], v12 offset:2560
    v_mfma_f32_32x32x16_bf16 v[224:239], v[244:247], v[60:63], v[224:239]
    ds_read_b64_tr_b16 v[148:149], v13 offset:2048
    ds_read_b64_tr_b16 v[150:151], v13 offset:2560
    s_waitcnt lgkmcnt(5)
    v_mfma_f32_32x32x16_bf16 v[208:223], v[248:251], v[64:67], v[208:223]
    ds_read_b128 v[72:75], v8 offset:0
    ds_read_b64_tr_b16 v[240:241], v12 offset:4096
    ds_read_b64_tr_b16 v[242:243], v12 offset:4608
    v_mfma_f32_32x32x16_bf16 v[224:239], v[252:255], v[64:67], v[224:239]
    ds_read_b64_tr_b16 v[244:245], v13 offset:4096
    ds_read_b64_tr_b16 v[246:247], v13 offset:4608
    s_waitcnt lgkmcnt(5)
    v_mfma_f32_32x32x16_bf16 v[208:223], v[144:147], v[68:71], v[208:223]
    ds_read_b128 v[76:79], v9 offset:0
    ds_read_b64_tr_b16 v[248:249], v12 offset:6144
    ds_read_b64_tr_b16 v[250:251], v12 offset:6656
    v_mfma_f32_32x32x16_bf16 v[224:239], v[148:151], v[68:71], v[224:239]
    ds_read_b64_tr_b16 v[252:253], v13 offset:6144
    ds_read_b64_tr_b16 v[254:255], v13 offset:6656
    s_waitcnt lgkmcnt(5)
    v_mfma_f32_32x32x16_bf16 v[208:223], v[240:243], v[72:75], v[208:223]
    v_mfma_f32_32x32x16_bf16 v[224:239], v[244:247], v[72:75], v[224:239]
    s_barrier
    ds_read_b128 v[80:83], v6 offset:24576
    ds_read_b64_tr_b16 v[144:145], v12 offset:24576
    ds_read_b64_tr_b16 v[146:147], v12 offset:25088
    ds_read_b64_tr_b16 v[148:149], v13 offset:24576
    ds_read_b64_tr_b16 v[150:151], v13 offset:25088
    s_waitcnt lgkmcnt(5)
    v_mfma_f32_32x32x16_bf16 v[208:223], v[248:251], v[76:79], v[208:223]
    ds_read_b128 v[84:87], v7 offset:24576
    ds_read_b64_tr_b16 v[240:241], v12 offset:26624
    ds_read_b64_tr_b16 v[242:243], v12 offset:27136
    v_mfma_f32_32x32x16_bf16 v[224:239], v[252:255], v[76:79], v[224:239]
    ds_read_b64_tr_b16 v[244:245], v13 offset:26624
    ds_read_b64_tr_b16 v[246:247], v13 offset:27136
    s_waitcnt lgkmcnt(5)
    v_mfma_f32_32x32x16_bf16 v[208:223], v[144:147], v[80:83], v[208:223]
    ds_read_b128 v[88:91], v8 offset:24576
    ds_read_b64_tr_b16 v[248:249], v12 offset:28672
    ds_read_b64_tr_b16 v[250:251], v12 offset:29184
    v_mfma_f32_32x32x16_bf16 v[224:239], v[148:151], v[80:83], v[224:239]
    ds_read_b64_tr_b16 v[252:253], v13 offset:28672
    ds_read_b64_tr_b16 v[254:255], v13 offset:29184
    s_waitcnt lgkmcnt(5)
    v_mfma_f32_32x32x16_bf16 v[208:223], v[240:243], v[84:87], v[208:223]
    ds_read_b128 v[92:95], v9 offset:24576
    ds_read_b64_tr_b16 v[144:145], v12 offset:30720
    ds_read_b64_tr_b16 v[146:147], v12 offset:31232
    v_mfma_f32_32x32x16_bf16 v[224:239], v[244:247], v[84:87], v[224:239]
    ds_read_b64_tr_b16 v[148:149], v13 offset:30720
    ds_read_b64_tr_b16 v[150:151], v13 offset:31232
    s_waitcnt lgkmcnt(5)
    v_mfma_f32_32x32x16_bf16 v[208:223], v[248:251], v[88:91], v[208:223]
    v_mfma_f32_32x32x16_bf16 v[224:239], v[252:255], v[88:91], v[224:239]
    s_barrier
    ds_read_b128 v[96:99], v2 offset:0
    ds_read_b64_tr_b16 v[240:241], v10 offset:0
    ds_read_b64_tr_b16 v[242:243], v10 offset:512
    ds_read_b64_tr_b16 v[244:245], v11 offset:0
    ds_read_b64_tr_b16 v[246:247], v11 offset:512
    s_waitcnt lgkmcnt(5)
    v_mfma_f32_32x32x16_bf16 v[208:223], v[144:147], v[92:95], v[208:223]
    ds_read_b128 v[100:103], v3 offset:0
    ds_read_b64_tr_b16 v[248:249], v10 offset:2048
    ds_read_b64_tr_b16 v[250:251], v10 offset:2560
    v_mfma_f32_32x32x16_bf16 v[224:239], v[148:151], v[92:95], v[224:239]
    ds_read_b64_tr_b16 v[252:253], v11 offset:2048
    ds_read_b64_tr_b16 v[254:255], v11 offset:2560
    s_waitcnt lgkmcnt(5)
    v_mfma_f32_32x32x16_bf16 v[208:223], v[240:243], v[96:99], v[208:223]
    ds_read_b128 v[104:107], v4 offset:0
    ds_read_b64_tr_b16 v[144:145], v10 offset:4096
    ds_read_b64_tr_b16 v[146:147], v10 offset:4608
    v_mfma_f32_32x32x16_bf16 v[224:239], v[244:247], v[96:99], v[224:239]
    ds_read_b64_tr_b16 v[148:149], v11 offset:4096
    ds_read_b64_tr_b16 v[150:151], v11 offset:4608
    s_waitcnt lgkmcnt(5)
    v_mfma_f32_32x32x16_bf16 v[208:223], v[248:251], v[100:103], v[208:223]
    ds_read_b128 v[108:111], v5 offset:0
    ds_read_b64_tr_b16 v[240:241], v10 offset:6144
    ds_read_b64_tr_b16 v[242:243], v10 offset:6656
    v_mfma_f32_32x32x16_bf16 v[224:239], v[252:255], v[100:103], v[224:239]
    ds_read_b64_tr_b16 v[244:245], v11 offset:6144
    ds_read_b64_tr_b16 v[246:247], v11 offset:6656
    s_waitcnt lgkmcnt(5)
    v_mfma_f32_32x32x16_bf16 v[208:223], v[144:147], v[104:107], v[208:223]
    v_mfma_f32_32x32x16_bf16 v[224:239], v[148:151], v[104:107], v[224:239]
    s_barrier
    ds_read_b128 v[112:115], v2 offset:24576
    ds_read_b64_tr_b16 v[248:249], v10 offset:24576
    ds_read_b64_tr_b16 v[250:251], v10 offset:25088
    ds_read_b64_tr_b16 v[252:253], v11 offset:24576
    ds_read_b64_tr_b16 v[254:255], v11 offset:25088
    s_waitcnt lgkmcnt(5)
    v_mfma_f32_32x32x16_bf16 v[208:223], v[240:243], v[108:111], v[208:223]
    ds_read_b128 v[116:119], v3 offset:24576
    ds_read_b64_tr_b16 v[144:145], v10 offset:26624
    ds_read_b64_tr_b16 v[146:147], v10 offset:27136
    v_mfma_f32_32x32x16_bf16 v[224:239], v[244:247], v[108:111], v[224:239]
    ds_read_b64_tr_b16 v[148:149], v11 offset:26624
    ds_read_b64_tr_b16 v[150:151], v11 offset:27136
    s_waitcnt lgkmcnt(5)
    v_mfma_f32_32x32x16_bf16 v[208:223], v[248:251], v[112:115], v[208:223]
    ds_read_b128 v[120:123], v4 offset:24576
    ds_read_b64_tr_b16 v[240:241], v10 offset:28672
    ds_read_b64_tr_b16 v[242:243], v10 offset:29184
    v_mfma_f32_32x32x16_bf16 v[224:239], v[252:255], v[112:115], v[224:239]
    ds_read_b64_tr_b16 v[244:245], v11 offset:28672
    ds_read_b64_tr_b16 v[246:247], v11 offset:29184
    s_waitcnt lgkmcnt(5)
    v_mfma_f32_32x32x16_bf16 v[208:223], v[144:147], v[116:119], v[208:223]
    ds_read_b128 v[124:127], v5 offset:24576
    ds_read_b64_tr_b16 v[248:249], v10 offset:30720
    ds_read_b64_tr_b16 v[250:251], v10 offset:31232
    v_mfma_f32_32x32x16_bf16 v[224:239], v[148:151], v[116:119], v[224:239]
    ds_read_b64_tr_b16 v[252:253], v11 offset:30720
    ds_read_b64_tr_b16 v[254:255], v11 offset:31232
    s_waitcnt lgkmcnt(5)
    v_mfma_f32_32x32x16_bf16 v[208:223], v[240:243], v[120:123], v[208:223]
    v_mfma_f32_32x32x16_bf16 v[224:239], v[244:247], v[120:123], v[224:239]
    s_barrier
    ds_read_b128 v[128:131], v6 offset:0
    ds_read_b64_tr_b16 v[144:145], v12 offset:0
    ds_read_b64_tr_b16 v[146:147], v12 offset:512
    ds_read_b64_tr_b16 v[148:149], v13 offset:0
    ds_read_b64_tr_b16 v[150:151], v13 offset:512
    s_waitcnt lgkmcnt(5)
    v_mfma_f32_32x32x16_bf16 v[208:223], v[248:251], v[124:127], v[208:223]
    ds_read_b128 v[132:135], v7 offset:0
    ds_read_b64_tr_b16 v[240:241], v12 offset:2048
    ds_read_b64_tr_b16 v[242:243], v12 offset:2560
    v_mfma_f32_32x32x16_bf16 v[224:239], v[252:255], v[124:127], v[224:239]
    ds_read_b64_tr_b16 v[244:245], v13 offset:2048
    ds_read_b64_tr_b16 v[246:247], v13 offset:2560
    s_waitcnt lgkmcnt(5)
    v_mfma_f32_32x32x16_bf16 v[208:223], v[144:147], v[128:131], v[208:223]
    ds_read_b128 v[136:139], v8 offset:0
    ds_read_b64_tr_b16 v[248:249], v12 offset:4096
    ds_read_b64_tr_b16 v[250:251], v12 offset:4608
    v_mfma_f32_32x32x16_bf16 v[224:239], v[148:151], v[128:131], v[224:239]
    ds_read_b64_tr_b16 v[252:253], v13 offset:4096
    ds_read_b64_tr_b16 v[254:255], v13 offset:4608
    s_waitcnt lgkmcnt(5)
    v_mfma_f32_32x32x16_bf16 v[208:223], v[240:243], v[132:135], v[208:223]
    ds_read_b128 v[140:143], v9 offset:0
    ds_read_b64_tr_b16 v[144:145], v12 offset:6144
    ds_read_b64_tr_b16 v[146:147], v12 offset:6656
    v_mfma_f32_32x32x16_bf16 v[224:239], v[244:247], v[132:135], v[224:239]
    ds_read_b64_tr_b16 v[148:149], v13 offset:6144
    ds_read_b64_tr_b16 v[150:151], v13 offset:6656
    s_waitcnt lgkmcnt(5)
    v_mfma_f32_32x32x16_bf16 v[208:223], v[248:251], v[136:139], v[208:223]
    v_mfma_f32_32x32x16_bf16 v[224:239], v[252:255], v[136:139], v[224:239]
    s_waitcnt lgkmcnt(0)
    v_mfma_f32_32x32x16_bf16 v[208:223], v[144:147], v[140:143], v[208:223]
    v_mfma_f32_32x32x16_bf16 v[224:239], v[148:151], v[140:143], v[224:239]
    s_nop 10
    v_cvt_pk_bf16_f32 v240, v208, v209
    v_cvt_pk_bf16_f32 v241, v210, v211
    v_cvt_pk_bf16_f32 v242, v212, v213
    v_cvt_pk_bf16_f32 v243, v214, v215
    s_nop 1
    v_permlane32_swap_b32 v240, v242
    v_permlane32_swap_b32 v241, v243
    buffer_store_dwordx4 v[240:243], v15, s[16:19], s47 offen offset:0 sc1
    v_cvt_pk_bf16_f32 v244, v216, v217
    v_cvt_pk_bf16_f32 v245, v218, v219
    v_cvt_pk_bf16_f32 v246, v220, v221
    v_cvt_pk_bf16_f32 v247, v222, v223
    s_nop 1
    v_permlane32_swap_b32 v244, v246
    v_permlane32_swap_b32 v245, v247
    buffer_store_dwordx4 v[244:247], v15, s[16:19], s47 offen offset:1024 sc1
    v_cvt_pk_bf16_f32 v248, v224, v225
    v_cvt_pk_bf16_f32 v249, v226, v227
    v_cvt_pk_bf16_f32 v250, v228, v229
    v_cvt_pk_bf16_f32 v251, v230, v231
    s_nop 1
    v_permlane32_swap_b32 v248, v250
    v_permlane32_swap_b32 v249, v251
    buffer_store_dwordx4 v[248:251], v15, s[16:19], s47 offen offset:2048 sc1
    v_cvt_pk_bf16_f32 v252, v232, v233
    v_cvt_pk_bf16_f32 v253, v234, v235
    v_cvt_pk_bf16_f32 v254, v236, v237
    v_cvt_pk_bf16_f32 v255, v238, v239
    s_nop 1
    v_permlane32_swap_b32 v252, v254
    v_permlane32_swap_b32 v253, v255
    buffer_store_dwordx4 v[252:255], v15, s[16:19], s47 offen offset:3072 sc1
    s_branch m_stored
m_vtype:
    s_lshl_b32 s3, s45, 10
    s_add_u32 s3, s3, 28672
    v_mul_u32_u24 v22, 7168, v21
    v_lshl_add_u32 v22, v20, 4, v22
    v_add_u32 v15, s3, v22
    v_add_u32 v16, 14336, v15
    s_barrier
    ds_read_b128 v[32:35], v2 offset:0
    ds_read_b64_tr_b16 v[144:145], v10 offset:0
    ds_read_b64_tr_b16 v[146:147], v10 offset:512
    ds_read_b64_tr_b16 v[148:149], v11 offset:0
    ds_read_b64_tr_b16 v[150:151], v11 offset:512
    ds_read_b128 v[36:39], v3 offset:0
    ds_read_b64_tr_b16 v[240:241], v10 offset:2048
    ds_read_b64_tr_b16 v[242:243], v10 offset:2560
    ds_read_b64_tr_b16 v[244:245], v11 offset:2048
    ds_read_b64_tr_b16 v[246:247], v11 offset:2560
    s_waitcnt lgkmcnt(5)
    v_mfma_f32_32x32x16_bf16 v[208:223], v[32:35], v[144:147], 0
    ds_read_b128 v[40:43], v4 offset:0
    ds_read_b64_tr_b16 v[248:249], v10 offset:4096
    ds_read_b64_tr_b16 v[250:251], v10 offset:4608
    v_mfma_f32_32x32x16_bf16 v[224:239], v[32:35], v[148:151], 0
    ds_read_b64_tr_b16 v[252:253], v11 offset:4096
    ds_read_b64_tr_b16 v[254:255], v11 offset:4608
    s_waitcnt lgkmcnt(5)
    v_mfma_f32_32x32x16_bf16 v[208:223], v[36:39], v[240:243], v[208:223]
    ds_read_b128 v[44:47], v5 offset:0
    ds_read_b64_tr_b16 v[144:145], v10 offset:6144
    ds_read_b64_tr_b16 v[146:147], v10 offset:6656
    v_mfma_f32_32x32x16_bf16 v[224:239], v[36:39], v[244:247], v[224:239]
    ds_read_b64_tr_b16 v[148:149], v11 offset:6144
    ds_read_b64_tr_b16 v[150:151], v11 offset:6656
    s_waitcnt lgkmcnt(5)
    v_mfma_f32_32x32x16_bf16 v[208:223], v[40:43], v[248:251], v[208:223]
    v_mfma_f32_32x32x16_bf16 v[224:239], v[40:43], v[252:255], v[224:239]
    s_barrier
    ds_read_b128 v[48:51], v2 offset:24576
    ds_read_b64_tr_b16 v[240:241], v10 offset:24576
    ds_read_b64_tr_b16 v[242:243], v10 offset:25088
    ds_read_b64_tr_b16 v[244:245], v11 offset:24576
    ds_read_b64_tr_b16 v[246:247], v11 offset:25088
    s_waitcnt lgkmcnt(5)
    v_mfma_f32_32x32x16_bf16 v[208:223], v[44:47], v[144:147], v[208:223]
    ds_read_b128 v[52:55], v3 offset:24576
    ds_read_b64_tr_b16 v[248:249], v10 offset:26624
    ds_read_b64_tr_b16 v[250:251], v10 offset:27136
    v_mfma_f32_32x32x16_bf16 v[224:239], v[44:47], v[148:151], v[224:239]
    ds_read_b64_tr_b16 v[252:253], v11 offset:26624
    ds_read_b64_tr_b16 v[254:255], v11 offset:27136
    s_waitcnt lgkmcnt(5)
    v_mfma_f32_32x32x16_bf16 v[208:223], v[48:51], v[240:243], v[208:223]
    ds_read_b128 v[56:59], v4 offset:24576
    ds_read_b64_tr_b16 v[144:145], v10 offset:28672
    ds_read_b64_tr_b16 v[146:147], v10 offset:29184
    v_mfma_f32_32x32x16_bf16 v[224:239], v[48:51], v[244:247], v[224:239]
    ds_read_b64_tr_b16 v[148:149], v11 offset:28672
    ds_read_b64_tr_b16 v[150:151], v11 offset:29184
    s_waitcnt lgkmcnt(5)
    v_mfma_f32_32x32x16_bf16 v[208:223], v[52:55], v[248:251], v[208:223]
    ds_read_b128 v[60:63], v5 offset:24576
    ds_read_b64_tr_b16 v[240:241], v10 offset:30720
    ds_read_b64_tr_b16 v[242:243], v10 offset:31232
    v_mfma_f32_32x32x16_bf16 v[224:239], v[52:55], v[252:255], v[224:239]
    ds_read_b64_tr_b16 v[244:245], v11 offset:30720
    ds_read_b64_tr_b16 v[246:247], v11 offset:31232
    s_waitcnt lgkmcnt(5)
    v_mfma_f32_32x32x16_bf16 v[208:223], v[56:59], v[144:147], v[208:223]
    v_mfma_f32_32x32x16_bf16 v[224:239], v[56:59], v[148:151], v[224:239]
    s_barrier
    ds_read_b128 v[64:67], v6 offset:0
    ds_read_b64_tr_b16 v[248:249], v12 offset:0
    ds_read_b64_tr_b16 v[250:251], v12 offset:512
    ds_read_b64_tr_b16 v[252:253], v13 offset:0
    ds_read_b64_tr_b16 v[254:255], v13 offset:512
    s_waitcnt lgkmcnt(5)
    v_mfma_f32_32x32x16_bf16 v[208:223], v[60:63], v[240:243], v[208:223]
    ds_read_b128 v[68:71], v7 offset:0
    ds_read_b64_tr_b16 v[144:145], v12 offset:2048
    ds_read_b64_tr_b16 v[146:147], v12 offset:2560
    v_mfma_f32_32x32x16_bf16 v[224:239], v[60:63], v[244:247], v[224:239]
    ds_read_b64_tr_b16 v[148:149], v13 offset:2048
    ds_read_b64_tr_b16 v[150:151], v13 offset:2560
    s_waitcnt lgkmcnt(5)
    v_mfma_f32_32x32x16_bf16 v[208:223], v[64:67], v[248:251], v[208:223]
    ds_read_b128 v[72:75], v8 offset:0
    ds_read_b64_tr_b16 v[240:241], v12 offset:4096
    ds_read_b64_tr_b16 v[242:243], v12 offset:4608
    v_mfma_f32_32x32x16_bf16 v[224:239], v[64:67], v[252:255], v[224:239]
    ds_read_b64_tr_b16 v[244:245], v13 offset:4096
    ds_read_b64_tr_b16 v[246:247], v13 offset:4608
    s_waitcnt lgkmcnt(5)
    v_mfma_f32_32x32x16_bf16 v[208:223], v[68:71], v[144:147], v[208:223]
    ds_read_b128 v[76:79], v9 offset:0
    ds_read_b64_tr_b16 v[248:249], v12 offset:6144
    ds_read_b64_tr_b16 v[250:251], v12 offset:6656
    v_mfma_f32_32x32x16_bf16 v[224:239], v[68:71], v[148:151], v[224:239]
    ds_read_b64_tr_b16 v[252:253], v13 offset:6144
    ds_read_b64_tr_b16 v[254:255], v13 offset:6656
    s_waitcnt lgkmcnt(5)
    v_mfma_f32_32x32x16_bf16 v[208:223], v[72:75], v[240:243], v[208:223]
    v_mfma_f32_32x32x16_bf16 v[224:239], v[72:75], v[244:247], v[224:239]
    s_barrier
    ds_read_b128 v[80:83], v6 offset:24576
    ds_read_b64_tr_b16 v[144:145], v12 offset:24576
    ds_read_b64_tr_b16 v[146:147], v12 offset:25088
    ds_read_b64_tr_b16 v[148:149], v13 offset:24576
    ds_read_b64_tr_b16 v[150:151], v13 offset:25088
    s_waitcnt lgkmcnt(5)
    v_mfma_f32_32x32x16_bf16 v[208:223], v[76:79], v[248:251], v[208:223]
    ds_read_b128 v[84:87], v7 offset:24576
    ds_read_b64_tr_b16 v[240:241], v12 offset:26624
    ds_read_b64_tr_b16 v[242:243], v12 offset:27136
    v_mfma_f32_32x32x16_bf16 v[224:239], v[76:79], v[252:255], v[224:239]
    ds_read_b64_tr_b16 v[244:245], v13 offset:26624
    ds_read_b64_tr_b16 v[246:247], v13 offset:27136
    s_waitcnt lgkmcnt(5)
    v_mfma_f32_32x32x16_bf16 v[208:223], v[80:83], v[144:147], v[208:223]
    ds_read_b128 v[88:91], v8 offset:24576
    ds_read_b64_tr_b16 v[248:249], v12 offset:28672
    ds_read_b64_tr_b16 v[250:251], v12 offset:29184
    v_mfma_f32_32x32x16_bf16 v[224:239], v[80:83], v[148:151], v[224:239]
    ds_read_b64_tr_b16 v[252:253], v13 offset:28672
    ds_read_b64_tr_b16 v[254:255], v13 offset:29184
    s_waitcnt lgkmcnt(5)
    v_mfma_f32_32x32x16_bf16 v[208:223], v[84:87], v[240:243], v[208:223]
    ds_read_b128 v[92:95], v9 offset:24576
    ds_read_b64_tr_b16 v[144:145], v12 offset:30720
    ds_read_b64_tr_b16 v[146:147], v12 offset:31232
    v_mfma_f32_32x32x16_bf16 v[224:239], v[84:87], v[244:247], v[224:239]
    ds_read_b64_tr_b16 v[148:149], v13 offset:30720
    ds_read_b64_tr_b16 v[150:151], v13 offset:31232
    s_waitcnt lgkmcnt(5)
    v_mfma_f32_32x32x16_bf16 v[208:223], v[88:91], v[248:251], v[208:223]
    v_mfma_f32_32x32x16_bf16 v[224:239], v[88:91], v[252:255], v[224:239]
    s_barrier
    ds_read_b128 v[96:99], v2 offset:0
    ds_read_b64_tr_b16 v[240:241], v10 offset:0
    ds_read_b64_tr_b16 v[242:243], v10 offset:512
    ds_read_b64_tr_b16 v[244:245], v11 offset:0
    ds_read_b64_tr_b16 v[246:247], v11 offset:512
    s_waitcnt lgkmcnt(5)
    v_mfma_f32_32x32x16_bf16 v[208:223], v[92:95], v[144:147], v[208:223]
    ds_read_b128 v[100:103], v3 offset:0
    ds_read_b64_tr_b16 v[248:249], v10 offset:2048
    ds_read_b64_tr_b16 v[250:251], v10 offset:2560
    v_mfma_f32_32x32x16_bf16 v[224:239], v[92:95], v[148:151], v[224:239]
    ds_read_b64_tr_b16 v[252:253], v11 offset:2048
    ds_read_b64_tr_b16 v[254:255], v11 offset:2560
    s_waitcnt lgkmcnt(5)
    v_mfma_f32_32x32x16_bf16 v[208:223], v[96:99], v[240:243], v[208:223]
    ds_read_b128 v[104:107], v4 offset:0
    ds_read_b64_tr_b16 v[144:145], v10 offset:4096
    ds_read_b64_tr_b16 v[146:147], v10 offset:4608
    v_mfma_f32_32x32x16_bf16 v[224:239], v[96:99], v[244:247], v[224:239]
    ds_read_b64_tr_b16 v[148:149], v11 offset:4096
    ds_read_b64_tr_b16 v[150:151], v11 offset:4608
    s_waitcnt lgkmcnt(5)
    v_mfma_f32_32x32x16_bf16 v[208:223], v[100:103], v[248:251], v[208:223]
    ds_read_b128 v[108:111], v5 offset:0
    ds_read_b64_tr_b16 v[240:241], v10 offset:6144
    ds_read_b64_tr_b16 v[242:243], v10 offset:6656
    v_mfma_f32_32x32x16_bf16 v[224:239], v[100:103], v[252:255], v[224:239]
    ds_read_b64_tr_b16 v[244:245], v11 offset:6144
    ds_read_b64_tr_b16 v[246:247], v11 offset:6656
    s_waitcnt lgkmcnt(5)
    v_mfma_f32_32x32x16_bf16 v[208:223], v[104:107], v[144:147], v[208:223]
    v_mfma_f32_32x32x16_bf16 v[224:239], v[104:107], v[148:151], v[224:239]
    s_barrier
    ds_read_b128 v[112:115], v2 offset:24576
    ds_read_b64_tr_b16 v[248:249], v10 offset:24576
    ds_read_b64_tr_b16 v[250:251], v10 offset:25088
    ds_read_b64_tr_b16 v[252:253], v11 offset:24576
    ds_read_b64_tr_b16 v[254:255], v11 offset:25088
    s_waitcnt lgkmcnt(5)
    v_mfma_f32_32x32x16_bf16 v[208:223], v[108:111], v[240:243], v[208:223]
    ds_read_b128 v[116:119], v3 offset:24576
    ds_read_b64_tr_b16 v[144:145], v10 offset:26624
    ds_read_b64_tr_b16 v[146:147], v10 offset:27136
    v_mfma_f32_32x32x16_bf16 v[224:239], v[108:111], v[244:247], v[224:239]
    ds_read_b64_tr_b16 v[148:149], v11 offset:26624
    ds_read_b64_tr_b16 v[150:151], v11 offset:27136
    s_waitcnt lgkmcnt(5)
    v_mfma_f32_32x32x16_bf16 v[208:223], v[112:115], v[248:251], v[208:223]
    ds_read_b128 v[120:123], v4 offset:24576
    ds_read_b64_tr_b16 v[240:241], v10 offset:28672
    ds_read_b64_tr_b16 v[242:243], v10 offset:29184
    v_mfma_f32_32x32x16_bf16 v[224:239], v[112:115], v[252:255], v[224:239]
    ds_read_b64_tr_b16 v[244:245], v11 offset:28672
    ds_read_b64_tr_b16 v[246:247], v11 offset:29184
    s_waitcnt lgkmcnt(5)
    v_mfma_f32_32x32x16_bf16 v[208:223], v[116:119], v[144:147], v[208:223]
    ds_read_b128 v[124:127], v5 offset:24576
    ds_read_b64_tr_b16 v[248:249], v10 offset:30720
    ds_read_b64_tr_b16 v[250:251], v10 offset:31232
    v_mfma_f32_32x32x16_bf16 v[224:239], v[116:119], v[148:151], v[224:239]
    ds_read_b64_tr_b16 v[252:253], v11 offset:30720
    ds_read_b64_tr_b16 v[254:255], v11 offset:31232
    s_waitcnt lgkmcnt(5)
    v_mfma_f32_32x32x16_bf16 v[208:223], v[120:123], v[240:243], v[208:223]
    v_mfma_f32_32x32x16_bf16 v[224:239], v[120:123], v[244:247], v[224:239]
    s_barrier
    ds_read_b128 v[128:131], v6 offset:0
    ds_read_b64_tr_b16 v[144:145], v12 offset:0
    ds_read_b64_tr_b16 v[146:147], v12 offset:512
    ds_read_b64_tr_b16 v[148:149], v13 offset:0
    ds_read_b64_tr_b16 v[150:151], v13 offset:512
    s_waitcnt lgkmcnt(5)
    v_mfma_f32_32x32x16_bf16 v[208:223], v[124:127], v[248:251], v[208:223]
    ds_read_b128 v[132:135], v7 offset:0
    ds_read_b64_tr_b16 v[240:241], v12 offset:2048
    ds_read_b64_tr_b16 v[242:243], v12 offset:2560
    v_mfma_f32_32x32x16_bf16 v[224:239], v[124:127], v[252:255], v[224:239]
    ds_read_b64_tr_b16 v[244:245], v13 offset:2048
    ds_read_b64_tr_b16 v[246:247], v13 offset:2560
    s_waitcnt lgkmcnt(5)
    v_mfma_f32_32x32x16_bf16 v[208:223], v[128:131], v[144:147], v[208:223]
    ds_read_b128 v[136:139], v8 offset:0
    ds_read_b64_tr_b16 v[248:249], v12 offset:4096
    ds_read_b64_tr_b16 v[250:251], v12 offset:4608
    v_mfma_f32_32x32x16_bf16 v[224:239], v[128:131], v[148:151], v[224:239]
    ds_read_b64_tr_b16 v[252:253], v13 offset:4096
    ds_read_b64_tr_b16 v[254:255], v13 offset:4608
    s_waitcnt lgkmcnt(5)
    v_mfma_f32_32x32x16_bf16 v[208:223], v[132:135], v[240:243], v[208:223]
    ds_read_b128 v[140:143], v9 offset:0
    ds_read_b64_tr_b16 v[144:145], v12 offset:6144
    ds_read_b64_tr_b16 v[146:147], v12 offset:6656
    v_mfma_f32_32x32x16_bf16 v[224:239], v[132:135], v[244:247], v[224:239]
    ds_read_b64_tr_b16 v[148:149], v13 offset:6144
    ds_read_b64_tr_b16 v[150:151], v13 offset:6656
    s_waitcnt lgkmcnt(5)
    v_mfma_f32_32x32x16_bf16 v[208:223], v[136:139], v[248:251], v[208:223]
    v_mfma_f32_32x32x16_bf16 v[224:239], v[136:139], v[252:255], v[224:239]
    s_waitcnt lgkmcnt(0)
    v_mfma_f32_32x32x16_bf16 v[208:223], v[140:143], v[144:147], v[208:223]
    v_mfma_f32_32x32x16_bf16 v[224:239], v[140:143], v[148:151], v[224:239]
    s_nop 10
    v_cvt_pk_bf16_f32 v240, v208, v209
    v_cvt_pk_bf16_f32 v241, v210, v211
    v_cvt_pk_bf16_f32 v242, v212, v213
    v_cvt_pk_bf16_f32 v243, v214, v215
    buffer_store_dwordx4 v[240:243], v15, s[16:19], s47 offen offset:0 sc1
    v_cvt_pk_bf16_f32 v244, v216, v217
    v_cvt_pk_bf16_f32 v245, v218, v219
    v_cvt_pk_bf16_f32 v246, v220, v221
    v_cvt_pk_bf16_f32 v247, v222, v223
    buffer_store_dwordx4 v[244:247], v16, s[16:19], s47 offen offset:0 sc1
    v_cvt_pk_bf16_f32 v248, v224, v225
    v_cvt_pk_bf16_f32 v249, v226, v227
    v_cvt_pk_bf16_f32 v250, v228, v229
    v_cvt_pk_bf16_f32 v251, v230, v231
    buffer_store_dwordx4 v[248:251], v15, s[16:19], s47 offen offset:512 sc1
    v_cvt_pk_bf16_f32 v252, v232, v233
    v_cvt_pk_bf16_f32 v253, v234, v235
    v_cvt_pk_bf16_f32 v254, v236, v237
    v_cvt_pk_bf16_f32 v255, v238, v239
    buffer_store_dwordx4 v[252:255], v16, s[16:19], s47 offen offset:512 sc1
m_stored:
    ds_write_b128 v17, v[240:243]
    ds_write_b128 v17, v[244:247] offset:1024
    ds_write_b128 v17, v[248:251] offset:2048
    ds_write_b128 v17, v[252:255] offset:3072
    s_mov_b64 exec, 1
    ds_add_u32 v157, v158 offset:56
    s_mov_b64 exec, -1
    s_waitcnt vmcnt(0) lgkmcnt(0)
    s_cmp_ge_u32 s44, 7
    s_cbranch_scc1 m_notlast
    s_mov_b64 exec, 1
    ds_add_rtn_u32 v8, v157, v158 offset:60
    s_waitcnt lgkmcnt(0)
    v_cmp_eq_u32 vcc, 3, v8
    s_and_b64 exec, exec, vcc
    s_cbranch_execz m_notlast
    buffer_store_dword v24, v25, s[16:19], s46 offen sc1
m_notlast:
    s_mov_b64 exec, -1
    s_mov_b32 s33, 200000
m_wq1:
    ds_read_b32 v8, v157 offset:16
    s_sub_u32 s33, s33, 1
    s_waitcnt lgkmcnt(0)
    v_cmp_gt_u32 vcc, 4, v8
    s_cbranch_scc1 m_wq1_ok
    s_cbranch_vccnz m_wq1
m_wq1_ok:
    ds_read_b64_tr_b16 v[224:225], v14 offset:0
    ds_read_b64_tr_b16 v[226:227], v14 offset:256
    ds_read_b64_tr_b16 v[228:229], v14 offset:1024
    ds_read_b64_tr_b16 v[230:231], v14 offset:1280
    ds_read_b64_tr_b16 v[232:233], v14 offset:2048
    ds_read_b64_tr_b16 v[234:235], v14 offset:2304
    ds_read_b64_tr_b16 v[236:237], v14 offset:3072
    ds_read_b64_tr_b16 v[238:239], v14 offset:3328
    ds_read_b64_tr_b16 v[240:241], v14 offset:4096
    ds_read_b64_tr_b16 v[242:243], v14 offset:4352
    s_waitcnt lgkmcnt(8)
    v_mfma_f32_32x32x16_bf16 v[208:223], v[224:227], v[32:35], 0
    ds_read_b64_tr_b16 v[244:245], v14 offset:5120
    ds_read_b64_tr_b16 v[246:247], v14 offset:5376
    s_waitcnt lgkmcnt(8)
    v_mfma_f32_32x32x16_bf16 v[208:223], v[228:231], v[36:39], v[208:223]
    ds_read_b64_tr_b16 v[224:225], v14 offset:6144
    ds_read_b64_tr_b16 v[226:227], v14 offset:6400
    s_waitcnt lgkmcnt(8)
    v_mfma_f32_32x32x16_bf16 v[208:223], v[232:235], v[40:43], v[208:223]
    ds_read_b64_tr_b16 v[228:229], v14 offset:7168
    ds_read_b64_tr_b16 v[230:231], v14 offset:7424
    s_waitcnt lgkmcnt(8)
    v_mfma_f32_32x32x16_bf16 v[208:223], v[236:239], v[44:47], v[208:223]
    ds_read_b64_tr_b16 v[232:233], v14 offset:8192
    ds_read_b64_tr_b16 v[234:235], v14 offset:8448
    s_waitcnt lgkmcnt(8)
    v_mfma_f32_32x32x16_bf16 v[208:223], v[240:243], v[48:51], v[208:223]
    ds_read_b64_tr_b16 v[236:237], v14 offset:9216
    ds_read_b64_tr_b16 v[238:239], v14 offset:9472
    s_waitcnt lgkmcnt(8)
    v_mfma_f32_32x32x16_bf16 v[208:223], v[244:247], v[52:55], v[208:223]
    ds_read_b64_tr_b16 v[240:241], v14 offset:10240
    ds_read_b64_tr_b16 v[242:243], v14 offset:10496
    s_waitcnt lgkmcnt(8)
    v_mfma_f32_32x32x16_bf16 v[208:223], v[224:227], v[56:59], v[208:223]
    ds_read_b64_tr_b16 v[244:245], v14 offset:11264
    ds_read_b64_tr_b16 v[246:247], v14 offset:11520
    s_waitcnt lgkmcnt(8)
    v_mfma_f32_32x32x16_bf16 v[208:223], v[228:231], v[60:63], v[208:223]
    ds_read_b64_tr_b16 v[224:225], v14 offset:12288
    ds_read_b64_tr_b16 v[226:227], v14 offset:12544
    s_waitcnt lgkmcnt(8)
    v_mfma_f32_32x32x16_bf16 v[208:223], v[232:235], v[64:67], v[208:223]
    ds_read_b64_tr_b16 v[228:229], v14 offset:13312
    ds_read_b64_tr_b16 v[230:231], v14 offset:13568
    s_waitcnt lgkmcnt(8)
    v_mfma_f32_32x32x16_bf16 v[208:223], v[236:239], v[68:71], v[208:223]
    ds_read_b64_tr_b16 v[232:233], v14 offset:14336
    ds_read_b64_tr_b16 v[234:235], v14 offset:14592
    s_waitcnt lgkmcnt(8)
    v_mfma_f32_32x32x16_bf16 v[208:223], v[240:243], v[72:75], v[208:223]
    ds_read_b64_tr_b16 v[236:237], v14 offset:15360
    ds_read_b64_tr_b16 v[238:239], v14 offset:15616
    s_waitcnt lgkmcnt(8)
    v_mfma_f32_32x32x16_bf16 v[208:223], v[244:247], v[76:79], v[208:223]
    s_waitcnt lgkmcnt(6)
    v_mfma_f32_32x32x16_bf16 v[208:223], v[224:227], v[80:83], v[208:223]
    s_waitcnt lgkmcnt(4)
    v_mfma_f32_32x32x16_bf16 v[208:223], v[228:231], v[84:87], v[208:223]
    s_waitcnt lgkmcnt(2)
    v_mfma_f32_32x32x16_bf16 v[208:223], v[232:235], v[88:91], v[208:223]
    s_waitcnt lgkmcnt(0)
    v_mfma_f32_32x32x16_bf16 v[208:223], v[236:239], v[92:95], v[208:223]
    s_mov_b32 s33, 200000
m_wq2:
    ds_read_b32 v8, v157 offset:20
    s_sub_u32 s33, s33, 1
    s_waitcnt lgkmcnt(0)
    v_cmp_gt_u32 vcc, 4, v8
    s_cbranch_scc1 m_wq2_ok
    s_cbranch_vccnz m_wq2
m_wq2_ok:
    ds_read_b64_tr_b16 v[240:241], v14 offset:16384
    ds_read_b64_tr_b16 v[242:243], v14 offset:16640
    ds_read_b64_tr_b16 v[244:245], v14 offset:17408
    ds_read_b64_tr_b16 v[246:247], v14 offset:17664
    ds_read_b64_tr_b16 v[224:225], v14 offset:18432
    ds_read_b64_tr_b16 v[226:227], v14 offset:18688
    ds_read_b64_tr_b16 v[228:229], v14 offset:19456
    ds_read_b64_tr_b16 v[230:231], v14 offset:19712
    ds_read_b64_tr_b16 v[232:233], v14 offset:20480
    ds_read_b64_tr_b16 v[234:235], v14 offset:20736
    s_waitcnt lgkmcnt(8)
    v_mfma_f32_32x32x16_bf16 v[208:223], v[240:243], v[96:99], v[208:223]
    ds_read_b64_tr_b16 v[236:237], v14 offset:21504
    ds_read_b64_tr_b16 v[238:239], v14 offset:21760
    s_waitcnt lgkmcnt(8)
    v_mfma_f32_32x32x16_bf16 v[208:223], v[244:247], v[100:103], v[208:223]
    ds_read_b64_tr_b16 v[240:241], v14 offset:22528
    ds_read_b64_tr_b16 v[242:243], v14 offset:22784
    s_waitcnt lgkmcnt(8)
    v_mfma_f32_32x32x16_bf16 v[208:223], v[224:227], v[104:107], v[208:223]
    ds_read_b64_tr_b16 v[244:245], v14 offset:23552
    ds_read_b64_tr_b16 v[246:247], v14 offset:23808
    s_waitcnt lgkmcnt(8)
    v_mfma_f32_32x32x16_bf16 v[208:223], v[228:231], v[108:111], v[208:223]
    ds_read_b64_tr_b16 v[224:225], v14 offset:24576
    ds_read_b64_tr_b16 v[226:227], v14 offset:24832
    s_waitcnt lgkmcnt(8)
    v_mfma_f32_32x32x16_bf16 v[208:223], v[232:235], v[112:115], v[208:223]
    ds_read_b64_tr_b16 v[228:229], v14 offset:25600
    ds_read_b64_tr_b16 v[230:231], v14 offset:25856
    s_waitcnt lgkmcnt(8)
    v_mfma_f32_32x32x16_bf16 v[208:223], v[236:239], v[116:119], v[208:223]
    ds_read_b64_tr_b16 v[232:233], v14 offset:26624
    ds_read_b64_tr_b16 v[234:235], v14 offset:26880
    s_waitcnt lgkmcnt(8)
    v_mfma_f32_32x32x16_bf16 v[208:223], v[240:243], v[120:123], v[208:223]
    ds_read_b64_tr_b16 v[236:237], v14 offset:27648
    ds_read_b64_tr_b16 v[238:239], v14 offset:27904
    s_waitcnt lgkmcnt(8)
    v_mfma_f32_32x32x16_bf16 v[208:223], v[244:247], v[124:127], v[208:223]
    s_waitcnt lgkmcnt(6)
    v_mfma_f32_32x32x16_bf16 v[208:223], v[224:227], v[128:131], v[208:223]
    s_waitcnt lgkmcnt(4)
    v_mfma_f32_32x32x16_bf16 v[208:223], v[228:231], v[132:135], v[208:223]
    s_waitcnt lgkmcnt(2)
    v_mfma_f32_32x32x16_bf16 v[208:223], v[232:235], v[136:139], v[208:223]
    s_waitcnt lgkmcnt(0)
    v_mfma_f32_32x32x16_bf16 v[208:223], v[236:239], v[140:143], v[208:223]
    s_nop 7
    v_mov_b32 v2, v26
    v_mov_b32 v10, 0x3e8b97f6
    v_add_u32 v5, s56, v1
    s_mov_b32 s37, 0x3c000000
    v_pk_mul_f32 v[208:209], v[208:209], v[10:11] op_sel_hi:[1,0]
    v_pk_mul_f32 v[210:211], v[210:211], v[10:11] op_sel_hi:[1,0]
    v_pk_mul_f32 v[212:213], v[212:213], v[10:11] op_sel_hi:[1,0]
    v_pk_mul_f32 v[214:215], v[214:215], v[10:11] op_sel_hi:[1,0]
    v_cvt_pk_bf16_f32 v16, v208, v209
    v_cvt_pk_bf16_f32 v17, v210, v211
    v_cvt_pk_bf16_f32 v18, v212, v213
    v_cvt_pk_bf16_f32 v19, v214, v215
    s_nop 1
    v_permlane32_swap_b32 v16, v18
    v_permlane32_swap_b32 v17, v19
    v_pk_mul_f32 v[216:217], v[216:217], v[10:11] op_sel_hi:[1,0]
    v_pk_mul_f32 v[218:219], v[218:219], v[10:11] op_sel_hi:[1,0]
    v_pk_mul_f32 v[220:221], v[220:221], v[10:11] op_sel_hi:[1,0]
    v_pk_mul_f32 v[222:223], v[222:223], v[10:11] op_sel_hi:[1,0]
    v_cvt_pk_bf16_f32 v20, v216, v217
    v_cvt_pk_bf16_f32 v21, v218, v219
    v_cvt_pk_bf16_f32 v22, v220, v221
    v_cvt_pk_bf16_f32 v23, v222, v223
    s_nop 1
    v_permlane32_swap_b32 v20, v22
    v_permlane32_swap_b32 v21, v23
    s_mov_b32 exec_lo, 0
    v_mov_b32 v22, 0
    v_mov_b32 v23, 0
    s_mov_b32 exec_lo, -1
    ds_write_b128 v5, v[16:19]
    v_pk_mov_b32 v[216:217], v[156:157], v[156:157] op_sel:[0,0]
    v_pk_mov_b32 v[218:219], v[156:157], v[156:157] op_sel:[0,0]
    v_pk_mov_b32 v[220:221], v[156:157], v[156:157] op_sel:[0,0]
    v_pk_mov_b32 v[222:223], v[156:157], v[156:157] op_sel:[0,0]
    v_pk_mov_b32 v[232:233], v[156:157], v[156:157] op_sel:[0,0]
    v_pk_mov_b32 v[234:235], v[156:157], v[156:157] op_sel:[0,0]
    v_pk_mov_b32 v[236:237], v[156:157], v[156:157] op_sel:[0,0]
    v_pk_mov_b32 v[238:239], v[156:157], v[156:157] op_sel:[0,0]
    v_pk_mov_b32 v[248:249], v[156:157], v[156:157] op_sel:[0,0]
    v_pk_mov_b32 v[250:251], v[156:157], v[156:157] op_sel:[0,0]
    v_pk_mov_b32 v[252:253], v[156:157], v[156:157] op_sel:[0,0]
    v_pk_mov_b32 v[254:255], v[156:157], v[156:157] op_sel:[0,0]
    v_add_u32 v9, s57, v1
    v_add_u32 v13, s61, v1
    v_add_u32 v10, s58, v1
    v_add_u32 v14, s62, v1
    v_add_u32 v11, s59, v1
    v_add_u32 v15, s63, v1
    s_mov_b32 exec_lo, 0x10001
    s_mov_b32 exec_hi, 0x10001
    buffer_load_dword v6, v159, s[16:19], s35 offen sc1
    s_mov_b32 s33, 200000
m_kvwait:
    s_waitcnt vmcnt(0)
    v_cmp_ne_u32 vcc, s65, v6
    s_sub_u32 s33, s33, 1
    s_cbranch_vccz m_kvready
    s_cbranch_scc1 m_kvready
    s_mov_b64 exec, vcc
    buffer_load_dword v6, v159, s[16:19], s35 offen sc1
    s_branch m_kvwait
m_kvready:
    s_mov_b64 exec, -1
    s_setprio 1
    buffer_load_dwordx4 v[160:163], v152, s[16:19], s30 offen sc1
    buffer_load_dwordx4 v[164:167], v153, s[16:19], s30 offen sc1
    s_mov_b64 exec, s[50:51]
    buffer_load_dwordx4 v[168:171], v154, s[16:19], s30 offen sc1
    buffer_load_dwordx4 v[172:175], v155, s[16:19], s30 offen sc1
    s_mov_b64 exec, -1
    buffer_load_dwordx4 v[176:179], v152, s[16:19], s54 offen sc1
    buffer_load_dwordx4 v[180:183], v153, s[16:19], s54 offen sc1
    s_mov_b64 exec, s[50:51]
    buffer_load_dwordx4 v[184:187], v154, s[16:19], s54 offen sc1
    buffer_load_dwordx4 v[188:191], v155, s[16:19], s54 offen sc1
    s_mov_b64 exec, -1
    buffer_load_dwordx4 v[192:195], v152, s[16:19], s55 offen sc1
    buffer_load_dwordx4 v[196:199], v153, s[16:19], s55 offen sc1
    s_mov_b64 exec, s[50:51]
    buffer_load_dwordx4 v[200:203], v154, s[16:19], s55 offen sc1
    buffer_load_dwordx4 v[204:207], v155, s[16:19], s55 offen sc1
    s_mov_b64 exec, -1
    v_add_u32 v4, s60, v1
    s_waitcnt vmcnt(10)
    v_mfma_f32_32x32x16_bf16 v[128:143], v[160:163], v[16:19], 0
    v_mfma_f32_32x32x16_bf16 v[112:127], v[164:167], v[20:23], v[128:143]
    v_cndmask_b32 v166, v166, v156, s[48:49]
    s_nop 10
    v_max3_f32 v8, v112, v113, v114
    v_max3_f32 v12, v115, v116, v117
    v_max3_f32 v8, v8, v118, v119
    v_max3_f32 v12, v12, v120, v121
    v_max3_f32 v8, v8, v122, v123
    v_max3_f32 v12, v12, v124, v125
    v_max3_f32 v8, v8, v126, v127
    v_max_f32 v8, v8, v12
    v_fma_f32 v8, abs(v8), s37, -v8
    s_mov_b32 exec_lo, 0
    v_cvt_pk_bf16_f32 v22, v8, 0
    s_mov_b32 exec_lo, -1
    ds_write_b128 v5, v[20:23] offset:1024
    v_mfma_f32_32x32x16_bf16 v[112:127], v[164:167], v[20:23], v[128:143]
    s_mov_b64 exec, 1
    ds_add_u32 v157, v158 offset:0
    s_mov_b64 exec, -1
    s_mov_b32 s37, 0xffff0000
    s_nop 4
.p2align 6
    s_waitcnt vmcnt(4)
    v_mfma_f32_32x32x16_bf16 v[128:143], v[176:179], v[16:19], 0
    v_cndmask_b32 v182, v182, v156, s[48:49]
    buffer_load_dwordx4 v[208:211], v152, s[16:19], s31 offen sc1
    v_exp_f32 v112, v112
    v_exp_f32 v113, v113
    v_exp_f32 v114, v114
    v_exp_f32 v115, v115
    v_cvt_pk_bf16_f32 v144, v112, v113
    v_cvt_pk_bf16_f32 v145, v114, v115
    v_mfma_f32_32x32x16_bf16 v[128:143], v[180:183], v[20:23], v[128:143]
    buffer_load_dwordx4 v[212:215], v153, s[16:19], s31 offen sc1
    v_exp_f32 v116, v116
    v_exp_f32 v117, v117
    v_exp_f32 v118, v118
    v_exp_f32 v119, v119
    v_cvt_pk_bf16_f32 v146, v116, v117
    v_cvt_pk_bf16_f32 v147, v118, v119
    v_exp_f32 v120, v120
    v_exp_f32 v121, v121
    v_exp_f32 v122, v122
    v_exp_f32 v123, v123
    v_cvt_pk_bf16_f32 v148, v120, v121
    v_cvt_pk_bf16_f32 v149, v122, v123
    v_mfma_f32_32x32x16_bf16 v[48:63], v[168:171], v[144:147], 0
    ds_read_b32 v8, v157
    s_mov_b64 exec, s[50:51]
    buffer_load_dwordx4 v[216:219], v154, s[16:19], s31 offen sc1
    buffer_load_dwordx4 v[220:223], v155, s[16:19], s31 offen sc1
    s_mov_b64 exec, -1
    s_add_u32 s31, s31, 57344
    v_exp_f32 v124, v124
    v_exp_f32 v125, v125
    v_exp_f32 v126, v126
    v_exp_f32 v127, v127
    v_cvt_pk_bf16_f32 v150, v124, v125
    v_cvt_pk_bf16_f32 v151, v126, v127
    s_waitcnt vmcnt(4)
    v_mfma_f32_32x32x16_bf16 v[112:127], v[192:195], v[16:19], 0
    v_cndmask_b32 v198, v198, v156, s[48:49]
    v_exp_f32 v128, v128
    v_exp_f32 v129, v129
    v_exp_f32 v130, v130
    v_exp_f32 v131, v131
    v_cvt_pk_bf16_f32 v144, v128, v129
    v_cvt_pk_bf16_f32 v145, v130, v131
    v_mfma_f32_32x32x16_bf16 v[112:127], v[196:199], v[20:23], v[112:127]
    s_mov_b32 s33, 200000
m_qwait:
    s_waitcnt lgkmcnt(0)
    v_cmp_gt_u32 vcc, 4, v8
    s_sub_u32 s33, s33, 1
    s_cbranch_vccz m_qwait_ok
    s_cbranch_scc1 m_qwait_ok
    ds_read_b32 v8, v157
    s_branch m_qwait
m_qwait_ok:
    ds_read_b128 v[24:27], v9
    ds_read_b128 v[28:31], v9 offset:1024
    ds_read_b128 v[32:35], v10
    ds_read_b128 v[36:39], v10 offset:1024
    ds_read_b128 v[40:43], v11
    ds_read_b128 v[44:47], v11 offset:1024
    v_exp_f32 v132, v132
    v_exp_f32 v133, v133
    v_exp_f32 v134, v134
    v_exp_f32 v135, v135
    v_cvt_pk_bf16_f32 v146, v132, v133
    v_cvt_pk_bf16_f32 v147, v134, v135
    v_mfma_f32_32x32x16_bf16 v[48:63], v[172:175], v[148:151], v[48:63]
    s_mov_b32 exec_lo, 0x11101110
    s_mov_b32 exec_hi, 0x11101110
    buffer_load_dword v6, v159, s[16:19], s35 offen sc1
    s_mov_b64 exec, -1
    v_exp_f32 v136, v136
    v_exp_f32 v137, v137
    v_exp_f32 v138, v138
    v_exp_f32 v139, v139
    v_cvt_pk_bf16_f32 v148, v136, v137
    v_cvt_pk_bf16_f32 v149, v138, v139
    v_mfma_f32_32x32x16_bf16 v[48:63], v[184:187], v[144:147], v[48:63]
    v_exp_f32 v140, v140
    v_exp_f32 v141, v141
    v_exp_f32 v142, v142
    v_exp_f32 v143, v143
    v_cvt_pk_bf16_f32 v150, v140, v141
    v_cvt_pk_bf16_f32 v151, v142, v143
    s_waitcnt lgkmcnt(0)
    v_mfma_f32_32x32x16_bf16 v[128:143], v[160:163], v[24:27], 0
    v_exp_f32 v112, v112
    v_exp_f32 v113, v113
    v_exp_f32 v114, v114
    v_exp_f32 v115, v115
    v_cvt_pk_bf16_f32 v144, v112, v113
    v_cvt_pk_bf16_f32 v145, v114, v115
    v_mfma_f32_32x32x16_bf16 v[128:143], v[164:167], v[28:31], v[128:143]
    v_exp_f32 v116, v116
    v_exp_f32 v117, v117
    v_exp_f32 v118, v118
    v_exp_f32 v119, v119
    v_cvt_pk_bf16_f32 v146, v116, v117
    v_cvt_pk_bf16_f32 v147, v118, v119
    v_mfma_f32_32x32x16_bf16 v[48:63], v[188:191], v[148:151], v[48:63]
    v_exp_f32 v120, v120
    v_exp_f32 v121, v121
    v_exp_f32 v122, v122
    v_exp_f32 v123, v123
    v_cvt_pk_bf16_f32 v148, v120, v121
    v_cvt_pk_bf16_f32 v149, v122, v123
    v_mfma_f32_32x32x16_bf16 v[48:63], v[200:203], v[144:147], v[48:63]
    v_exp_f32 v124, v124
    v_exp_f32 v125, v125
    v_exp_f32 v126, v126
    v_exp_f32 v127, v127
    v_cvt_pk_bf16_f32 v150, v124, v125
    v_cvt_pk_bf16_f32 v151, v126, v127
    v_mfma_f32_32x32x16_bf16 v[112:127], v[160:163], v[32:35], 0
    v_exp_f32 v128, v128
    v_exp_f32 v129, v129
    v_exp_f32 v130, v130
    v_exp_f32 v131, v131
    v_cvt_pk_bf16_f32 v144, v128, v129
    v_cvt_pk_bf16_f32 v145, v130, v131
    v_mfma_f32_32x32x16_bf16 v[112:127], v[164:167], v[36:39], v[112:127]
    v_exp_f32 v132, v132
    v_exp_f32 v133, v133
    v_exp_f32 v134, v134
    v_exp_f32 v135, v135
    v_cvt_pk_bf16_f32 v146, v132, v133
    v_cvt_pk_bf16_f32 v147, v134, v135
    v_mfma_f32_32x32x16_bf16 v[48:63], v[204:207], v[148:151], v[48:63]
    v_exp_f32 v136, v136
    v_exp_f32 v137, v137
    v_exp_f32 v138, v138
    v_exp_f32 v139, v139
    v_cvt_pk_bf16_f32 v148, v136, v137
    v_cvt_pk_bf16_f32 v149, v138, v139
    v_mfma_f32_32x32x16_bf16 v[64:79], v[168:171], v[144:147], 0
    v_exp_f32 v140, v140
    v_exp_f32 v141, v141
    v_exp_f32 v142, v142
    v_exp_f32 v143, v143
    v_cvt_pk_bf16_f32 v150, v140, v141
    v_cvt_pk_bf16_f32 v151, v142, v143
    v_mfma_f32_32x32x16_bf16 v[128:143], v[160:163], v[40:43], 0
    v_exp_f32 v112, v112
    v_exp_f32 v113, v113
    v_exp_f32 v114, v114
    v_exp_f32 v115, v115
    v_cvt_pk_bf16_f32 v144, v112, v113
    v_cvt_pk_bf16_f32 v145, v114, v115
    v_mfma_f32_32x32x16_bf16 v[128:143], v[164:167], v[44:47], v[128:143]
    v_exp_f32 v116, v116
    v_exp_f32 v117, v117
    v_exp_f32 v118, v118
    v_exp_f32 v119, v119
    v_cvt_pk_bf16_f32 v146, v116, v117
    v_cvt_pk_bf16_f32 v147, v118, v119
    v_mfma_f32_32x32x16_bf16 v[64:79], v[172:175], v[148:151], v[64:79]
    v_exp_f32 v120, v120
    v_exp_f32 v121, v121
    v_exp_f32 v122, v122
    v_exp_f32 v123, v123
    v_cvt_pk_bf16_f32 v148, v120, v121
    v_cvt_pk_bf16_f32 v149, v122, v123
    v_mfma_f32_32x32x16_bf16 v[80:95], v[168:171], v[144:147], 0
    v_exp_f32 v124, v124
    v_exp_f32 v125, v125
    v_exp_f32 v126, v126
    v_exp_f32 v127, v127
    v_cvt_pk_bf16_f32 v150, v124, v125
    v_cvt_pk_bf16_f32 v151, v126, v127
    v_mfma_f32_32x32x16_bf16 v[112:127], v[176:179], v[24:27], 0
    s_mov_b32 exec_lo, 0x11101110
    s_mov_b32 exec_hi, 0x11101110
    s_waitcnt vmcnt(0)
    s_mov_b32 s33, 200000
m_seg1:
    v_cmp_ne_u32 vcc, s65, v6
    s_sub_u32 s33, s33, 1
    s_cbranch_vccz m_seg1_ok
    s_cbranch_scc1 m_seg1_ok
    buffer_load_dword v6, v159, s[16:19], s35 offen sc1
    s_waitcnt vmcnt(0)
    s_branch m_seg1
m_seg1_ok:
    s_mov_b64 exec, -1
    buffer_load_dwordx4 v[224:227], v152, s[16:19], s31 offen sc1
    v_exp_f32 v128, v128
    v_exp_f32 v129, v129
    v_exp_f32 v130, v130
    v_exp_f32 v131, v131
    v_cvt_pk_bf16_f32 v144, v128, v129
    v_cvt_pk_bf16_f32 v145, v130, v131
    v_mfma_f32_32x32x16_bf16 v[112:127], v[180:183], v[28:31], v[112:127]
    buffer_load_dwordx4 v[228:231], v153, s[16:19], s31 offen sc1
    v_exp_f32 v132, v132
    v_exp_f32 v133, v133
    v_exp_f32 v134, v134
    v_exp_f32 v135, v135
    v_cvt_pk_bf16_f32 v146, v132, v133
    v_cvt_pk_bf16_f32 v147, v134, v135
    v_mfma_f32_32x32x16_bf16 v[80:95], v[172:175], v[148:151], v[80:95]
    v_exp_f32 v136, v136
    v_exp_f32 v137, v137
    v_exp_f32 v138, v138
    v_exp_f32 v139, v139
    v_cvt_pk_bf16_f32 v148, v136, v137
    v_cvt_pk_bf16_f32 v149, v138, v139
    v_mfma_f32_32x32x16_bf16 v[96:111], v[168:171], v[144:147], 0
    s_mov_b64 exec, s[50:51]
    buffer_load_dwordx4 v[232:235], v154, s[16:19], s31 offen sc1
    buffer_load_dwordx4 v[236:239], v155, s[16:19], s31 offen sc1
    s_mov_b64 exec, -1
    s_add_u32 s31, s31, 57344
    v_exp_f32 v140, v140
    v_exp_f32 v141, v141
    v_exp_f32 v142, v142
    v_exp_f32 v143, v143
    v_cvt_pk_bf16_f32 v150, v140, v141
    v_cvt_pk_bf16_f32 v151, v142, v143
    v_mfma_f32_32x32x16_bf16 v[128:143], v[176:179], v[32:35], 0
    buffer_load_dwordx4 v[240:243], v152, s[16:19], s31 offen sc1
    v_exp_f32 v112, v112
    v_exp_f32 v113, v113
    v_exp_f32 v114, v114
    v_exp_f32 v115, v115
    v_cvt_pk_bf16_f32 v144, v112, v113
    v_cvt_pk_bf16_f32 v145, v114, v115
    v_mfma_f32_32x32x16_bf16 v[128:143], v[180:183], v[36:39], v[128:143]
    buffer_load_dwordx4 v[244:247], v153, s[16:19], s31 offen sc1
    v_exp_f32 v116, v116
    v_exp_f32 v117, v117
    v_exp_f32 v118, v118
    v_exp_f32 v119, v119
    v_cvt_pk_bf16_f32 v146, v116, v117
    v_cvt_pk_bf16_f32 v147, v118, v119
    v_mfma_f32_32x32x16_bf16 v[96:111], v[172:175], v[148:151], v[96:111]
    v_exp_f32 v120, v120
    v_exp_f32 v121, v121
    v_exp_f32 v122, v122
    v_exp_f32 v123, v123
    v_cvt_pk_bf16_f32 v148, v120, v121
    v_cvt_pk_bf16_f32 v149, v122, v123
    v_mfma_f32_32x32x16_bf16 v[64:79], v[184:187], v[144:147], v[64:79]
    s_mov_b64 exec, s[50:51]
    buffer_load_dwordx4 v[248:251], v154, s[16:19], s31 offen sc1
    buffer_load_dwordx4 v[252:255], v155, s[16:19], s31 offen sc1
    s_mov_b64 exec, -1
    s_add_u32 s31, s31, 57344
    v_exp_f32 v124, v124
    v_exp_f32 v125, v125
    v_exp_f32 v126, v126
    v_exp_f32 v127, v127
    v_cvt_pk_bf16_f32 v150, v124, v125
    v_cvt_pk_bf16_f32 v151, v126, v127
    v_mfma_f32_32x32x16_bf16 v[112:127], v[176:179], v[40:43], 0
    buffer_load_dwordx4 v[160:163], v152, s[16:19], s31 offen sc1
    v_exp_f32 v128, v128
    v_exp_f32 v129, v129
    v_exp_f32 v130, v130
    v_exp_f32 v131, v131
    v_cvt_pk_bf16_f32 v144, v128, v129
    v_cvt_pk_bf16_f32 v145, v130, v131
    v_mfma_f32_32x32x16_bf16 v[112:127], v[180:183], v[44:47], v[112:127]
    buffer_load_dwordx4 v[164:167], v153, s[16:19], s31 offen sc1
    v_exp_f32 v132, v132
    v_exp_f32 v133, v133
    v_exp_f32 v134, v134
    v_exp_f32 v135, v135
    v_cvt_pk_bf16_f32 v146, v132, v133
    v_cvt_pk_bf16_f32 v147, v134, v135
    v_mfma_f32_32x32x16_bf16 v[64:79], v[188:191], v[148:151], v[64:79]
    v_exp_f32 v136, v136
    v_exp_f32 v137, v137
    v_exp_f32 v138, v138
    v_exp_f32 v139, v139
    v_cvt_pk_bf16_f32 v148, v136, v137
    v_cvt_pk_bf16_f32 v149, v138, v139
    v_mfma_f32_32x32x16_bf16 v[80:95], v[184:187], v[144:147], v[80:95]
    s_mov_b64 exec, 1
    ds_add_u32 v157, v158 offset:48
    s_mov_b64 exec, -1
    s_mov_b64 exec, s[50:51]
    buffer_load_dwordx4 v[168:171], v154, s[16:19], s31 offen sc1
    buffer_load_dwordx4 v[172:175], v155, s[16:19], s31 offen sc1
    s_mov_b64 exec, -1
    s_add_u32 s31, s31, 57344
    v_exp_f32 v140, v140
    v_exp_f32 v141, v141
    v_exp_f32 v142, v142
    v_exp_f32 v143, v143
    v_cvt_pk_bf16_f32 v150, v140, v141
    v_cvt_pk_bf16_f32 v151, v142, v143
    v_mfma_f32_32x32x16_bf16 v[128:143], v[192:195], v[24:27], 0
    v_exp_f32 v112, v112
    v_exp_f32 v113, v113
    v_exp_f32 v114, v114
    v_exp_f32 v115, v115
    v_cvt_pk_bf16_f32 v144, v112, v113
    v_cvt_pk_bf16_f32 v145, v114, v115
    v_mfma_f32_32x32x16_bf16 v[128:143], v[196:199], v[28:31], v[128:143]
    v_exp_f32 v116, v116
    v_exp_f32 v117, v117
    v_exp_f32 v118, v118
    v_exp_f32 v119, v119
    v_cvt_pk_bf16_f32 v146, v116, v117
    v_cvt_pk_bf16_f32 v147, v118, v119
    v_mfma_f32_32x32x16_bf16 v[80:95], v[188:191], v[148:151], v[80:95]
    v_exp_f32 v120, v120
    v_exp_f32 v121, v121
    v_exp_f32 v122, v122
    v_exp_f32 v123, v123
    v_cvt_pk_bf16_f32 v148, v120, v121
    v_cvt_pk_bf16_f32 v149, v122, v123
    v_mfma_f32_32x32x16_bf16 v[96:111], v[184:187], v[144:147], v[96:111]
    v_exp_f32 v124, v124
    v_exp_f32 v125, v125
    v_exp_f32 v126, v126
    v_exp_f32 v127, v127
    v_cvt_pk_bf16_f32 v150, v124, v125
    v_cvt_pk_bf16_f32 v151, v126, v127
    v_mfma_f32_32x32x16_bf16 v[112:127], v[192:195], v[32:35], 0
    v_exp_f32 v128, v128
    v_exp_f32 v129, v129
    v_exp_f32 v130, v130
    v_exp_f32 v131, v131
    v_cvt_pk_bf16_f32 v144, v128, v129
    v_cvt_pk_bf16_f32 v145, v130, v131
    v_mfma_f32_32x32x16_bf16 v[112:127], v[196:199], v[36:39], v[112:127]
    v_exp_f32 v132, v132
    v_exp_f32 v133, v133
    v_exp_f32 v134, v134
    v_exp_f32 v135, v135
    v_cvt_pk_bf16_f32 v146, v132, v133
    v_cvt_pk_bf16_f32 v147, v134, v135
    v_mfma_f32_32x32x16_bf16 v[96:111], v[188:191], v[148:151], v[96:111]
    v_exp_f32 v136, v136
    v_exp_f32 v137, v137
    v_exp_f32 v138, v138
    v_exp_f32 v139, v139
    v_cvt_pk_bf16_f32 v148, v136, v137
    v_cvt_pk_bf16_f32 v149, v138, v139
    v_mfma_f32_32x32x16_bf16 v[64:79], v[200:203], v[144:147], v[64:79]
    v_exp_f32 v140, v140
    v_exp_f32 v141, v141
    v_exp_f32 v142, v142
    v_exp_f32 v143, v143
    v_cvt_pk_bf16_f32 v150, v140, v141
    v_cvt_pk_bf16_f32 v151, v142, v143
    v_mfma_f32_32x32x16_bf16 v[128:143], v[192:195], v[40:43], 0
    v_exp_f32 v112, v112
    v_exp_f32 v113, v113
    v_exp_f32 v114, v114
    v_exp_f32 v115, v115
    v_cvt_pk_bf16_f32 v144, v112, v113
    v_cvt_pk_bf16_f32 v145, v114, v115
    v_mfma_f32_32x32x16_bf16 v[128:143], v[196:199], v[44:47], v[128:143]
    v_exp_f32 v116, v116
    v_exp_f32 v117, v117
    v_exp_f32 v118, v118
    v_exp_f32 v119, v119
    v_cvt_pk_bf16_f32 v146, v116, v117
    v_cvt_pk_bf16_f32 v147, v118, v119
    v_mfma_f32_32x32x16_bf16 v[64:79], v[204:207], v[148:151], v[64:79]
    v_exp_f32 v120, v120
    v_exp_f32 v121, v121
    v_exp_f32 v122, v122
    v_exp_f32 v123, v123
    v_cvt_pk_bf16_f32 v148, v120, v121
    v_cvt_pk_bf16_f32 v149, v122, v123
    v_mfma_f32_32x32x16_bf16 v[80:95], v[200:203], v[144:147], v[80:95]
    v_exp_f32 v124, v124
    v_exp_f32 v125, v125
    v_exp_f32 v126, v126
    v_exp_f32 v127, v127
    v_cvt_pk_bf16_f32 v150, v124, v125
    v_cvt_pk_bf16_f32 v151, v126, v127
    s_waitcnt vmcnt(13)
    v_mfma_f32_32x32x16_bf16 v[112:127], v[208:211], v[16:19], 0
    v_cndmask_b32 v214, v214, v156, s[48:49]
    v_exp_f32 v128, v128
    v_exp_f32 v129, v129
    v_exp_f32 v130, v130
    v_exp_f32 v131, v131
    v_cvt_pk_bf16_f32 v144, v128, v129
    v_cvt_pk_bf16_f32 v145, v130, v131
    v_mfma_f32_32x32x16_bf16 v[112:127], v[212:215], v[20:23], v[112:127]
    v_exp_f32 v132, v132
    v_exp_f32 v133, v133
    v_exp_f32 v134, v134
    v_exp_f32 v135, v135
    v_cvt_pk_bf16_f32 v146, v132, v133
    v_cvt_pk_bf16_f32 v147, v134, v135
    v_mfma_f32_32x32x16_bf16 v[80:95], v[204:207], v[148:151], v[80:95]
    v_exp_f32 v136, v136
    v_exp_f32 v137, v137
    v_exp_f32 v138, v138
    v_exp_f32 v139, v139
    v_cvt_pk_bf16_f32 v148, v136, v137
    v_cvt_pk_bf16_f32 v149, v138, v139
    v_mfma_f32_32x32x16_bf16 v[96:111], v[200:203], v[144:147], v[96:111]
    v_exp_f32 v140, v140
    v_exp_f32 v141, v141
    v_exp_f32 v142, v142
    v_exp_f32 v143, v143
    v_cvt_pk_bf16_f32 v150, v140, v141
    v_cvt_pk_bf16_f32 v151, v142, v143
    v_mfma_f32_32x32x16_bf16 v[128:143], v[208:211], v[24:27], 0
    v_exp_f32 v112, v112
    v_exp_f32 v113, v113
    v_exp_f32 v114, v114
    v_exp_f32 v115, v115
    v_cvt_pk_bf16_f32 v144, v112, v113
    v_cvt_pk_bf16_f32 v145, v114, v115
    v_mfma_f32_32x32x16_bf16 v[128:143], v[212:215], v[28:31], v[128:143]
    v_exp_f32 v116, v116
    v_exp_f32 v117, v117
    v_exp_f32 v118, v118
    v_exp_f32 v119, v119
    v_cvt_pk_bf16_f32 v146, v116, v117
    v_cvt_pk_bf16_f32 v147, v118, v119
    v_mfma_f32_32x32x16_bf16 v[96:111], v[204:207], v[148:151], v[96:111]
    v_exp_f32 v120, v120
    v_exp_f32 v121, v121
    v_exp_f32 v122, v122
    v_exp_f32 v123, v123
    v_cvt_pk_bf16_f32 v148, v120, v121
    v_cvt_pk_bf16_f32 v149, v122, v123
    v_mfma_f32_32x32x16_bf16 v[48:63], v[216:219], v[144:147], v[48:63]
    v_exp_f32 v124, v124
    v_exp_f32 v125, v125
    v_exp_f32 v126, v126
    v_exp_f32 v127, v127
    v_cvt_pk_bf16_f32 v150, v124, v125
    v_cvt_pk_bf16_f32 v151, v126, v127
    v_mfma_f32_32x32x16_bf16 v[112:127], v[208:211], v[32:35], 0
    v_exp_f32 v128, v128
    v_exp_f32 v129, v129
    v_exp_f32 v130, v130
    v_exp_f32 v131, v131
    v_cvt_pk_bf16_f32 v144, v128, v129
    v_cvt_pk_bf16_f32 v145, v130, v131
    v_mfma_f32_32x32x16_bf16 v[112:127], v[212:215], v[36:39], v[112:127]
    v_exp_f32 v132, v132
    v_exp_f32 v133, v133
    v_exp_f32 v134, v134
    v_exp_f32 v135, v135
    v_cvt_pk_bf16_f32 v146, v132, v133
    v_cvt_pk_bf16_f32 v147, v134, v135
    v_mfma_f32_32x32x16_bf16 v[48:63], v[220:223], v[148:151], v[48:63]
    v_exp_f32 v136, v136
    v_exp_f32 v137, v137
    v_exp_f32 v138, v138
    v_exp_f32 v139, v139
    v_cvt_pk_bf16_f32 v148, v136, v137
    v_cvt_pk_bf16_f32 v149, v138, v139
    v_mfma_f32_32x32x16_bf16 v[64:79], v[216:219], v[144:147], v[64:79]
    v_exp_f32 v140, v140
    v_exp_f32 v141, v141
    v_exp_f32 v142, v142
    v_exp_f32 v143, v143
    v_cvt_pk_bf16_f32 v150, v140, v141
    v_cvt_pk_bf16_f32 v151, v142, v143
    v_mfma_f32_32x32x16_bf16 v[128:143], v[208:211], v[40:43], 0
    v_exp_f32 v112, v112
    v_exp_f32 v113, v113
    v_exp_f32 v114, v114
    v_exp_f32 v115, v115
    v_cvt_pk_bf16_f32 v144, v112, v113
    v_cvt_pk_bf16_f32 v145, v114, v115
    v_mfma_f32_32x32x16_bf16 v[128:143], v[212:215], v[44:47], v[128:143]
    v_exp_f32 v116, v116
    v_exp_f32 v117, v117
    v_exp_f32 v118, v118
    v_exp_f32 v119, v119
    v_cvt_pk_bf16_f32 v146, v116, v117
    v_cvt_pk_bf16_f32 v147, v118, v119
    v_mfma_f32_32x32x16_bf16 v[64:79], v[220:223], v[148:151], v[64:79]
    v_exp_f32 v120, v120
    v_exp_f32 v121, v121
    v_exp_f32 v122, v122
    v_exp_f32 v123, v123
    v_cvt_pk_bf16_f32 v148, v120, v121
    v_cvt_pk_bf16_f32 v149, v122, v123
    v_mfma_f32_32x32x16_bf16 v[80:95], v[216:219], v[144:147], v[80:95]
    v_exp_f32 v124, v124
    v_exp_f32 v125, v125
    v_exp_f32 v126, v126
    v_exp_f32 v127, v127
    v_cvt_pk_bf16_f32 v150, v124, v125
    v_cvt_pk_bf16_f32 v151, v126, v127
    s_waitcnt vmcnt(8)
    v_mfma_f32_32x32x16_bf16 v[112:127], v[224:227], v[16:19], 0
    v_cndmask_b32 v230, v230, v156, s[48:49]
    v_exp_f32 v128, v128
    v_exp_f32 v129, v129
    v_exp_f32 v130, v130
    v_exp_f32 v131, v131
    v_cvt_pk_bf16_f32 v144, v128, v129
    v_cvt_pk_bf16_f32 v145, v130, v131
    v_mfma_f32_32x32x16_bf16 v[112:127], v[228:231], v[20:23], v[112:127]
    v_exp_f32 v132, v132
    v_exp_f32 v133, v133
    v_exp_f32 v134, v134
    v_exp_f32 v135, v135
    v_cvt_pk_bf16_f32 v146, v132, v133
    v_cvt_pk_bf16_f32 v147, v134, v135
    v_mfma_f32_32x32x16_bf16 v[80:95], v[220:223], v[148:151], v[80:95]
    v_exp_f32 v136, v136
    v_exp_f32 v137, v137
    v_exp_f32 v138, v138
    v_exp_f32 v139, v139
    v_cvt_pk_bf16_f32 v148, v136, v137
    v_cvt_pk_bf16_f32 v149, v138, v139
    v_mfma_f32_32x32x16_bf16 v[96:111], v[216:219], v[144:147], v[96:111]
    v_exp_f32 v140, v140
    v_exp_f32 v141, v141
    v_exp_f32 v142, v142
    v_exp_f32 v143, v143
    v_cvt_pk_bf16_f32 v150, v140, v141
    v_cvt_pk_bf16_f32 v151, v142, v143
    v_mfma_f32_32x32x16_bf16 v[128:143], v[224:227], v[24:27], 0
    v_exp_f32 v112, v112
    v_exp_f32 v113, v113
    v_exp_f32 v114, v114
    v_exp_f32 v115, v115
    v_cvt_pk_bf16_f32 v144, v112, v113
    v_cvt_pk_bf16_f32 v145, v114, v115
    v_mfma_f32_32x32x16_bf16 v[128:143], v[228:231], v[28:31], v[128:143]
    v_exp_f32 v116, v116
    v_exp_f32 v117, v117
    v_exp_f32 v118, v118
    v_exp_f32 v119, v119
    v_cvt_pk_bf16_f32 v146, v116, v117
    v_cvt_pk_bf16_f32 v147, v118, v119
    v_mfma_f32_32x32x16_bf16 v[96:111], v[220:223], v[148:151], v[96:111]
    v_exp_f32 v120, v120
    v_exp_f32 v121, v121
    v_exp_f32 v122, v122
    v_exp_f32 v123, v123
    v_cvt_pk_bf16_f32 v148, v120, v121
    v_cvt_pk_bf16_f32 v149, v122, v123
    v_mfma_f32_32x32x16_bf16 v[48:63], v[232:235], v[144:147], v[48:63]
    v_exp_f32 v124, v124
    v_exp_f32 v125, v125
    v_exp_f32 v126, v126
    v_exp_f32 v127, v127
    v_cvt_pk_bf16_f32 v150, v124, v125
    v_cvt_pk_bf16_f32 v151, v126, v127
    v_mfma_f32_32x32x16_bf16 v[112:127], v[224:227], v[32:35], 0
    v_exp_f32 v128, v128
    v_exp_f32 v129, v129
    v_exp_f32 v130, v130
    v_exp_f32 v131, v131
    v_cvt_pk_bf16_f32 v144, v128, v129
    v_cvt_pk_bf16_f32 v145, v130, v131
    v_mfma_f32_32x32x16_bf16 v[112:127], v[228:231], v[36:39], v[112:127]
    v_exp_f32 v132, v132
    v_exp_f32 v133, v133
    v_exp_f32 v134, v134
    v_exp_f32 v135, v135
    v_cvt_pk_bf16_f32 v146, v132, v133
    v_cvt_pk_bf16_f32 v147, v134, v135
    v_mfma_f32_32x32x16_bf16 v[48:63], v[236:239], v[148:151], v[48:63]
    v_exp_f32 v136, v136
    v_exp_f32 v137, v137
    v_exp_f32 v138, v138
    v_exp_f32 v139, v139
    v_cvt_pk_bf16_f32 v148, v136, v137
    v_cvt_pk_bf16_f32 v149, v138, v139
    v_mfma_f32_32x32x16_bf16 v[64:79], v[232:235], v[144:147], v[64:79]
    v_exp_f32 v140, v140
    v_exp_f32 v141, v141
    v_exp_f32 v142, v142
    v_exp_f32 v143, v143
    v_cvt_pk_bf16_f32 v150, v140, v141
    v_cvt_pk_bf16_f32 v151, v142, v143
    v_mfma_f32_32x32x16_bf16 v[128:143], v[224:227], v[40:43], 0
    v_exp_f32 v112, v112
    v_exp_f32 v113, v113
    v_exp_f32 v114, v114
    v_exp_f32 v115, v115
    v_cvt_pk_bf16_f32 v144, v112, v113
    v_cvt_pk_bf16_f32 v145, v114, v115
    v_mfma_f32_32x32x16_bf16 v[128:143], v[228:231], v[44:47], v[128:143]
    v_exp_f32 v116, v116
    v_exp_f32 v117, v117
    v_exp_f32 v118, v118
    v_exp_f32 v119, v119
    v_cvt_pk_bf16_f32 v146, v116, v117
    v_cvt_pk_bf16_f32 v147, v118, v119
    v_mfma_f32_32x32x16_bf16 v[64:79], v[236:239], v[148:151], v[64:79]
    v_exp_f32 v120, v120
    v_exp_f32 v121, v121
    v_exp_f32 v122, v122
    v_exp_f32 v123, v123
    v_cvt_pk_bf16_f32 v148, v120, v121
    v_cvt_pk_bf16_f32 v149, v122, v123
    v_mfma_f32_32x32x16_bf16 v[80:95], v[232:235], v[144:147], v[80:95]
    v_exp_f32 v124, v124
    v_exp_f32 v125, v125
    v_exp_f32 v126, v126
    v_exp_f32 v127, v127
    v_cvt_pk_bf16_f32 v150, v124, v125
    v_cvt_pk_bf16_f32 v151, v126, v127
    s_waitcnt vmcnt(4)
    v_mfma_f32_32x32x16_bf16 v[112:127], v[240:243], v[16:19], 0
    v_cndmask_b32 v246, v246, v156, s[48:49]
    v_exp_f32 v128, v128
    v_exp_f32 v129, v129
    v_exp_f32 v130, v130
    v_exp_f32 v131, v131
    v_cvt_pk_bf16_f32 v144, v128, v129
    v_cvt_pk_bf16_f32 v145, v130, v131
    v_mfma_f32_32x32x16_bf16 v[112:127], v[244:247], v[20:23], v[112:127]
    v_exp_f32 v132, v132
    v_exp_f32 v133, v133
    v_exp_f32 v134, v134
    v_exp_f32 v135, v135
    v_cvt_pk_bf16_f32 v146, v132, v133
    v_cvt_pk_bf16_f32 v147, v134, v135
    v_mfma_f32_32x32x16_bf16 v[80:95], v[236:239], v[148:151], v[80:95]
    v_exp_f32 v136, v136
    v_exp_f32 v137, v137
    v_exp_f32 v138, v138
    v_exp_f32 v139, v139
    v_cvt_pk_bf16_f32 v148, v136, v137
    v_cvt_pk_bf16_f32 v149, v138, v139
    v_mfma_f32_32x32x16_bf16 v[96:111], v[232:235], v[144:147], v[96:111]
    v_exp_f32 v140, v140
    v_exp_f32 v141, v141
    v_exp_f32 v142, v142
    v_exp_f32 v143, v143
    v_cvt_pk_bf16_f32 v150, v140, v141
    v_cvt_pk_bf16_f32 v151, v142, v143
    v_mfma_f32_32x32x16_bf16 v[128:143], v[240:243], v[24:27], 0
    v_exp_f32 v112, v112
    v_exp_f32 v113, v113
    v_exp_f32 v114, v114
    v_exp_f32 v115, v115
    v_cvt_pk_bf16_f32 v144, v112, v113
    v_cvt_pk_bf16_f32 v145, v114, v115
    v_mfma_f32_32x32x16_bf16 v[128:143], v[244:247], v[28:31], v[128:143]
    v_exp_f32 v116, v116
    v_exp_f32 v117, v117
    v_exp_f32 v118, v118
    v_exp_f32 v119, v119
    v_cvt_pk_bf16_f32 v146, v116, v117
    v_cvt_pk_bf16_f32 v147, v118, v119
    v_mfma_f32_32x32x16_bf16 v[96:111], v[236:239], v[148:151], v[96:111]
    v_exp_f32 v120, v120
    v_exp_f32 v121, v121
    v_exp_f32 v122, v122
    v_exp_f32 v123, v123
    v_cvt_pk_bf16_f32 v148, v120, v121
    v_cvt_pk_bf16_f32 v149, v122, v123
    v_mfma_f32_32x32x16_bf16 v[48:63], v[248:251], v[144:147], v[48:63]
    v_exp_f32 v124, v124
    v_exp_f32 v125, v125
    v_exp_f32 v126, v126
    v_exp_f32 v127, v127
    v_cvt_pk_bf16_f32 v150, v124, v125
    v_cvt_pk_bf16_f32 v151, v126, v127
    v_mfma_f32_32x32x16_bf16 v[112:127], v[240:243], v[32:35], 0
    buffer_load_dwordx4 v[176:179], v152, s[16:19], s31 offen sc1
    v_exp_f32 v128, v128
    v_exp_f32 v129, v129
    v_exp_f32 v130, v130
    v_exp_f32 v131, v131
    v_cvt_pk_bf16_f32 v144, v128, v129
    v_cvt_pk_bf16_f32 v145, v130, v131
    v_mfma_f32_32x32x16_bf16 v[112:127], v[244:247], v[36:39], v[112:127]
    buffer_load_dwordx4 v[180:183], v153, s[16:19], s31 offen sc1
    v_exp_f32 v132, v132
    v_exp_f32 v133, v133
    v_exp_f32 v134, v134
    v_exp_f32 v135, v135
    v_cvt_pk_bf16_f32 v146, v132, v133
    v_cvt_pk_bf16_f32 v147, v134, v135
    v_mfma_f32_32x32x16_bf16 v[48:63], v[252:255], v[148:151], v[48:63]
    v_exp_f32 v136, v136
    v_exp_f32 v137, v137
    v_exp_f32 v138, v138
    v_exp_f32 v139, v139
    v_cvt_pk_bf16_f32 v148, v136, v137
    v_cvt_pk_bf16_f32 v149, v138, v139
    v_mfma_f32_32x32x16_bf16 v[64:79], v[248:251], v[144:147], v[64:79]
    s_mov_b64 exec, s[50:51]
    buffer_load_dwordx4 v[184:187], v154, s[16:19], s31 offen sc1
    buffer_load_dwordx4 v[188:191], v155, s[16:19], s31 offen sc1
    s_mov_b64 exec, -1
    s_add_u32 s31, s31, 57344
    v_exp_f32 v140, v140
    v_exp_f32 v141, v141
    v_exp_f32 v142, v142
    v_exp_f32 v143, v143
    v_cvt_pk_bf16_f32 v150, v140, v141
    v_cvt_pk_bf16_f32 v151, v142, v143
    v_mfma_f32_32x32x16_bf16 v[128:143], v[240:243], v[40:43], 0
    buffer_load_dwordx4 v[192:195], v152, s[16:19], s31 offen sc1
    v_exp_f32 v112, v112
    v_exp_f32 v113, v113
    v_exp_f32 v114, v114
    v_exp_f32 v115, v115
    v_cvt_pk_bf16_f32 v144, v112, v113
    v_cvt_pk_bf16_f32 v145, v114, v115
    v_mfma_f32_32x32x16_bf16 v[128:143], v[244:247], v[44:47], v[128:143]
    buffer_load_dwordx4 v[196:199], v153, s[16:19], s31 offen sc1
    v_exp_f32 v116, v116
    v_exp_f32 v117, v117
    v_exp_f32 v118, v118
    v_exp_f32 v119, v119
    v_cvt_pk_bf16_f32 v146, v116, v117
    v_cvt_pk_bf16_f32 v147, v118, v119
    v_mfma_f32_32x32x16_bf16 v[64:79], v[252:255], v[148:151], v[64:79]
    v_exp_f32 v120, v120
    v_exp_f32 v121, v121
    v_exp_f32 v122, v122
    v_exp_f32 v123, v123
    v_cvt_pk_bf16_f32 v148, v120, v121
    v_cvt_pk_bf16_f32 v149, v122, v123
    v_mfma_f32_32x32x16_bf16 v[80:95], v[248:251], v[144:147], v[80:95]
    s_mov_b64 exec, s[50:51]
    buffer_load_dwordx4 v[200:203], v154, s[16:19], s31 offen sc1
    buffer_load_dwordx4 v[204:207], v155, s[16:19], s31 offen sc1
    s_mov_b64 exec, -1
    s_add_u32 s31, s31, 57344
    v_exp_f32 v124, v124
    v_exp_f32 v125, v125
    v_exp_f32 v126, v126
    v_exp_f32 v127, v127
    v_cvt_pk_bf16_f32 v150, v124, v125
    v_cvt_pk_bf16_f32 v151, v126, v127
    s_waitcnt vmcnt(8)
    v_mfma_f32_32x32x16_bf16 v[112:127], v[160:163], v[16:19], 0
    v_cndmask_b32 v166, v166, v156, s[48:49]
    buffer_load_dwordx4 v[208:211], v152, s[16:19], s31 offen sc1
    v_exp_f32 v128, v128
    v_exp_f32 v129, v129
    v_exp_f32 v130, v130
    v_exp_f32 v131, v131
    v_cvt_pk_bf16_f32 v144, v128, v129
    v_cvt_pk_bf16_f32 v145, v130, v131
    v_mfma_f32_32x32x16_bf16 v[112:127], v[164:167], v[20:23], v[112:127]
    buffer_load_dwordx4 v[212:215], v153, s[16:19], s31 offen sc1
    v_exp_f32 v132, v132
    v_exp_f32 v133, v133
    v_exp_f32 v134, v134
    v_exp_f32 v135, v135
    v_cvt_pk_bf16_f32 v146, v132, v133
    v_cvt_pk_bf16_f32 v147, v134, v135
    v_mfma_f32_32x32x16_bf16 v[80:95], v[252:255], v[148:151], v[80:95]
    v_exp_f32 v136, v136
    v_exp_f32 v137, v137
    v_exp_f32 v138, v138
    v_exp_f32 v139, v139
    v_cvt_pk_bf16_f32 v148, v136, v137
    v_cvt_pk_bf16_f32 v149, v138, v139
    v_mfma_f32_32x32x16_bf16 v[96:111], v[248:251], v[144:147], v[96:111]
    s_mov_b64 exec, 1
    ds_add_u32 v157, v158 offset:48
    s_mov_b64 exec, -1
    s_mov_b64 exec, s[50:51]
    buffer_load_dwordx4 v[216:219], v154, s[16:19], s31 offen sc1
    buffer_load_dwordx4 v[220:223], v155, s[16:19], s31 offen sc1
    s_mov_b64 exec, -1
    s_add_u32 s31, s31, 57344
    v_exp_f32 v140, v140
    v_exp_f32 v141, v141
    v_exp_f32 v142, v142
    v_exp_f32 v143, v143
    v_cvt_pk_bf16_f32 v150, v140, v141
    v_cvt_pk_bf16_f32 v151, v142, v143
    v_mfma_f32_32x32x16_bf16 v[128:143], v[160:163], v[24:27], 0
    buffer_load_dwordx4 v[224:227], v152, s[16:19], s31 offen sc1
    v_exp_f32 v112, v112
    v_exp_f32 v113, v113
    v_exp_f32 v114, v114
    v_exp_f32 v115, v115
    v_cvt_pk_bf16_f32 v144, v112, v113
    v_cvt_pk_bf16_f32 v145, v114, v115
    v_mfma_f32_32x32x16_bf16 v[128:143], v[164:167], v[28:31], v[128:143]
    buffer_load_dwordx4 v[228:231], v153, s[16:19], s31 offen sc1
    v_exp_f32 v116, v116
    v_exp_f32 v117, v117
    v_exp_f32 v118, v118
    v_exp_f32 v119, v119
    v_cvt_pk_bf16_f32 v146, v116, v117
    v_cvt_pk_bf16_f32 v147, v118, v119
    v_mfma_f32_32x32x16_bf16 v[96:111], v[252:255], v[148:151], v[96:111]
    v_exp_f32 v120, v120
    v_exp_f32 v121, v121
    v_exp_f32 v122, v122
    v_exp_f32 v123, v123
    v_cvt_pk_bf16_f32 v148, v120, v121
    v_cvt_pk_bf16_f32 v149, v122, v123
    v_mfma_f32_32x32x16_bf16 v[48:63], v[168:171], v[144:147], v[48:63]
    s_mov_b64 exec, s[50:51]
    buffer_load_dwordx4 v[232:235], v154, s[16:19], s31 offen sc1
    buffer_load_dwordx4 v[236:239], v155, s[16:19], s31 offen sc1
    s_mov_b64 exec, -1
    s_add_u32 s31, s31, 57344
    v_exp_f32 v124, v124
    v_exp_f32 v125, v125
    v_exp_f32 v126, v126
    v_exp_f32 v127, v127
    v_cvt_pk_bf16_f32 v150, v124, v125
    v_cvt_pk_bf16_f32 v151, v126, v127
    v_mfma_f32_32x32x16_bf16 v[112:127], v[160:163], v[32:35], 0
    buffer_load_dwordx4 v[240:243], v152, s[16:19], s31 offen sc1
    v_exp_f32 v128, v128
    v_exp_f32 v129, v129
    v_exp_f32 v130, v130
    v_exp_f32 v131, v131
    v_cvt_pk_bf16_f32 v144, v128, v129
    v_cvt_pk_bf16_f32 v145, v130, v131
    v_mfma_f32_32x32x16_bf16 v[112:127], v[164:167], v[36:39], v[112:127]
    buffer_load_dwordx4 v[244:247], v153, s[16:19], s31 offen sc1
    v_exp_f32 v132, v132
    v_exp_f32 v133, v133
    v_exp_f32 v134, v134
    v_exp_f32 v135, v135
    v_cvt_pk_bf16_f32 v146, v132, v133
    v_cvt_pk_bf16_f32 v147, v134, v135
    v_mfma_f32_32x32x16_bf16 v[48:63], v[172:175], v[148:151], v[48:63]
    v_exp_f32 v136, v136
    v_exp_f32 v137, v137
    v_exp_f32 v138, v138
    v_exp_f32 v139, v139
    v_cvt_pk_bf16_f32 v148, v136, v137
    v_cvt_pk_bf16_f32 v149, v138, v139
    v_mfma_f32_32x32x16_bf16 v[64:79], v[168:171], v[144:147], v[64:79]
    s_mov_b64 exec, s[50:51]
    buffer_load_dwordx4 v[248:251], v154, s[16:19], s31 offen sc1
    buffer_load_dwordx4 v[252:255], v155, s[16:19], s31 offen sc1
    s_mov_b64 exec, -1
    s_add_u32 s31, s31, 57344
    v_exp_f32 v140, v140
    v_exp_f32 v141, v141
    v_exp_f32 v142, v142
    v_exp_f32 v143, v143
    v_cvt_pk_bf16_f32 v150, v140, v141
    v_cvt_pk_bf16_f32 v151, v142, v143
    v_mfma_f32_32x32x16_bf16 v[128:143], v[160:163], v[40:43], 0
    v_exp_f32 v112, v112
    v_exp_f32 v113, v113
    v_exp_f32 v114, v114
    v_exp_f32 v115, v115
    v_cvt_pk_bf16_f32 v144, v112, v113
    v_cvt_pk_bf16_f32 v145, v114, v115
    v_mfma_f32_32x32x16_bf16 v[128:143], v[164:167], v[44:47], v[128:143]
    v_exp_f32 v116, v116
    v_exp_f32 v117, v117
    v_exp_f32 v118, v118
    v_exp_f32 v119, v119
    v_cvt_pk_bf16_f32 v146, v116, v117
    v_cvt_pk_bf16_f32 v147, v118, v119
    v_mfma_f32_32x32x16_bf16 v[64:79], v[172:175], v[148:151], v[64:79]
    v_exp_f32 v120, v120
    v_exp_f32 v121, v121
    v_exp_f32 v122, v122
    v_exp_f32 v123, v123
    v_cvt_pk_bf16_f32 v148, v120, v121
    v_cvt_pk_bf16_f32 v149, v122, v123
    v_mfma_f32_32x32x16_bf16 v[80:95], v[168:171], v[144:147], v[80:95]
    v_exp_f32 v124, v124
    v_exp_f32 v125, v125
    v_exp_f32 v126, v126
    v_exp_f32 v127, v127
    v_cvt_pk_bf16_f32 v150, v124, v125
    v_cvt_pk_bf16_f32 v151, v126, v127
    s_waitcnt vmcnt(16)
    v_mfma_f32_32x32x16_bf16 v[112:127], v[176:179], v[16:19], 0
    v_cndmask_b32 v182, v182, v156, s[48:49]
    v_exp_f32 v128, v128
    v_exp_f32 v129, v129
    v_exp_f32 v130, v130
    v_exp_f32 v131, v131
    v_cvt_pk_bf16_f32 v144, v128, v129
    v_cvt_pk_bf16_f32 v145, v130, v131
    v_mfma_f32_32x32x16_bf16 v[112:127], v[180:183], v[20:23], v[112:127]
    v_exp_f32 v132, v132
    v_exp_f32 v133, v133
    v_exp_f32 v134, v134
    v_exp_f32 v135, v135
    v_cvt_pk_bf16_f32 v146, v132, v133
    v_cvt_pk_bf16_f32 v147, v134, v135
    v_mfma_f32_32x32x16_bf16 v[80:95], v[172:175], v[148:151], v[80:95]
    v_exp_f32 v136, v136
    v_exp_f32 v137, v137
    v_exp_f32 v138, v138
    v_exp_f32 v139, v139
    v_cvt_pk_bf16_f32 v148, v136, v137
    v_cvt_pk_bf16_f32 v149, v138, v139
    v_mfma_f32_32x32x16_bf16 v[96:111], v[168:171], v[144:147], v[96:111]
    v_exp_f32 v140, v140
    v_exp_f32 v141, v141
    v_exp_f32 v142, v142
    v_exp_f32 v143, v143
    v_cvt_pk_bf16_f32 v150, v140, v141
    v_cvt_pk_bf16_f32 v151, v142, v143
    v_mfma_f32_32x32x16_bf16 v[128:143], v[176:179], v[24:27], 0
    v_exp_f32 v112, v112
    v_exp_f32 v113, v113
    v_exp_f32 v114, v114
    v_exp_f32 v115, v115
    v_cvt_pk_bf16_f32 v144, v112, v113
    v_cvt_pk_bf16_f32 v145, v114, v115
    v_mfma_f32_32x32x16_bf16 v[128:143], v[180:183], v[28:31], v[128:143]
    v_exp_f32 v116, v116
    v_exp_f32 v117, v117
    v_exp_f32 v118, v118
    v_exp_f32 v119, v119
    v_cvt_pk_bf16_f32 v146, v116, v117
    v_cvt_pk_bf16_f32 v147, v118, v119
    v_mfma_f32_32x32x16_bf16 v[96:111], v[172:175], v[148:151], v[96:111]
    v_exp_f32 v120, v120
    v_exp_f32 v121, v121
    v_exp_f32 v122, v122
    v_exp_f32 v123, v123
    v_cvt_pk_bf16_f32 v148, v120, v121
    v_cvt_pk_bf16_f32 v149, v122, v123
    v_mfma_f32_32x32x16_bf16 v[48:63], v[184:187], v[144:147], v[48:63]
    v_exp_f32 v124, v124
    v_exp_f32 v125, v125
    v_exp_f32 v126, v126
    v_exp_f32 v127, v127
    v_cvt_pk_bf16_f32 v150, v124, v125
    v_cvt_pk_bf16_f32 v151, v126, v127
    v_mfma_f32_32x32x16_bf16 v[112:127], v[176:179], v[32:35], 0
    buffer_load_dwordx4 v[160:163], v152, s[16:19], s31 offen sc1
    v_exp_f32 v128, v128
    v_exp_f32 v129, v129
    v_exp_f32 v130, v130
    v_exp_f32 v131, v131
    v_cvt_pk_bf16_f32 v144, v128, v129
    v_cvt_pk_bf16_f32 v145, v130, v131
    v_mfma_f32_32x32x16_bf16 v[112:127], v[180:183], v[36:39], v[112:127]
    buffer_load_dwordx4 v[164:167], v153, s[16:19], s31 offen sc1
    v_exp_f32 v132, v132
    v_exp_f32 v133, v133
    v_exp_f32 v134, v134
    v_exp_f32 v135, v135
    v_cvt_pk_bf16_f32 v146, v132, v133
    v_cvt_pk_bf16_f32 v147, v134, v135
    v_mfma_f32_32x32x16_bf16 v[48:63], v[188:191], v[148:151], v[48:63]
    v_exp_f32 v136, v136
    v_exp_f32 v137, v137
    v_exp_f32 v138, v138
    v_exp_f32 v139, v139
    v_cvt_pk_bf16_f32 v148, v136, v137
    v_cvt_pk_bf16_f32 v149, v138, v139
    v_mfma_f32_32x32x16_bf16 v[64:79], v[184:187], v[144:147], v[64:79]
    s_mov_b64 exec, s[50:51]
    buffer_load_dwordx4 v[168:171], v154, s[16:19], s31 offen sc1
    buffer_load_dwordx4 v[172:175], v155, s[16:19], s31 offen sc1
    s_mov_b64 exec, -1
    s_add_u32 s31, s31, 57344
    v_exp_f32 v140, v140
    v_exp_f32 v141, v141
    v_exp_f32 v142, v142
    v_exp_f32 v143, v143
    v_cvt_pk_bf16_f32 v150, v140, v141
    v_cvt_pk_bf16_f32 v151, v142, v143
    v_mfma_f32_32x32x16_bf16 v[128:143], v[176:179], v[40:43], 0
    v_exp_f32 v112, v112
    v_exp_f32 v113, v113
    v_exp_f32 v114, v114
    v_exp_f32 v115, v115
    v_cvt_pk_bf16_f32 v144, v112, v113
    v_cvt_pk_bf16_f32 v145, v114, v115
    v_mfma_f32_32x32x16_bf16 v[128:143], v[180:183], v[44:47], v[128:143]
    v_exp_f32 v116, v116
    v_exp_f32 v117, v117
    v_exp_f32 v118, v118
    v_exp_f32 v119, v119
    v_cvt_pk_bf16_f32 v146, v116, v117
    v_cvt_pk_bf16_f32 v147, v118, v119
    v_mfma_f32_32x32x16_bf16 v[64:79], v[188:191], v[148:151], v[64:79]
    v_exp_f32 v120, v120
    v_exp_f32 v121, v121
    v_exp_f32 v122, v122
    v_exp_f32 v123, v123
    v_cvt_pk_bf16_f32 v148, v120, v121
    v_cvt_pk_bf16_f32 v149, v122, v123
    v_mfma_f32_32x32x16_bf16 v[80:95], v[184:187], v[144:147], v[80:95]
    v_exp_f32 v124, v124
    v_exp_f32 v125, v125
    v_exp_f32 v126, v126
    v_exp_f32 v127, v127
    v_cvt_pk_bf16_f32 v150, v124, v125
    v_cvt_pk_bf16_f32 v151, v126, v127
    s_waitcnt vmcnt(16)
    v_mfma_f32_32x32x16_bf16 v[112:127], v[192:195], v[16:19], 0
    v_cndmask_b32 v198, v198, v156, s[48:49]
    v_exp_f32 v128, v128
    v_exp_f32 v129, v129
    v_exp_f32 v130, v130
    v_exp_f32 v131, v131
    v_cvt_pk_bf16_f32 v144, v128, v129
    v_cvt_pk_bf16_f32 v145, v130, v131
    v_mfma_f32_32x32x16_bf16 v[112:127], v[196:199], v[20:23], v[112:127]
    v_exp_f32 v132, v132
    v_exp_f32 v133, v133
    v_exp_f32 v134, v134
    v_exp_f32 v135, v135
    v_cvt_pk_bf16_f32 v146, v132, v133
    v_cvt_pk_bf16_f32 v147, v134, v135
    v_mfma_f32_32x32x16_bf16 v[80:95], v[188:191], v[148:151], v[80:95]
    v_exp_f32 v136, v136
    v_exp_f32 v137, v137
    v_exp_f32 v138, v138
    v_exp_f32 v139, v139
    v_cvt_pk_bf16_f32 v148, v136, v137
    v_cvt_pk_bf16_f32 v149, v138, v139
    v_mfma_f32_32x32x16_bf16 v[96:111], v[184:187], v[144:147], v[96:111]
    v_exp_f32 v140, v140
    v_exp_f32 v141, v141
    v_exp_f32 v142, v142
    v_exp_f32 v143, v143
    v_cvt_pk_bf16_f32 v150, v140, v141
    v_cvt_pk_bf16_f32 v151, v142, v143
    v_mfma_f32_32x32x16_bf16 v[128:143], v[192:195], v[24:27], 0
    v_exp_f32 v112, v112
    v_exp_f32 v113, v113
    v_exp_f32 v114, v114
    v_exp_f32 v115, v115
    v_cvt_pk_bf16_f32 v144, v112, v113
    v_cvt_pk_bf16_f32 v145, v114, v115
    v_mfma_f32_32x32x16_bf16 v[128:143], v[196:199], v[28:31], v[128:143]
    v_exp_f32 v116, v116
    v_exp_f32 v117, v117
    v_exp_f32 v118, v118
    v_exp_f32 v119, v119
    v_cvt_pk_bf16_f32 v146, v116, v117
    v_cvt_pk_bf16_f32 v147, v118, v119
    v_mfma_f32_32x32x16_bf16 v[96:111], v[188:191], v[148:151], v[96:111]
    v_exp_f32 v120, v120
    v_exp_f32 v121, v121
    v_exp_f32 v122, v122
    v_exp_f32 v123, v123
    v_cvt_pk_bf16_f32 v148, v120, v121
    v_cvt_pk_bf16_f32 v149, v122, v123
    v_mfma_f32_32x32x16_bf16 v[48:63], v[200:203], v[144:147], v[48:63]
    v_exp_f32 v124, v124
    v_exp_f32 v125, v125
    v_exp_f32 v126, v126
    v_exp_f32 v127, v127
    v_cvt_pk_bf16_f32 v150, v124, v125
    v_cvt_pk_bf16_f32 v151, v126, v127
    v_mfma_f32_32x32x16_bf16 v[112:127], v[192:195], v[32:35], 0
    buffer_load_dwordx4 v[176:179], v152, s[16:19], s31 offen sc1
    v_exp_f32 v128, v128
    v_exp_f32 v129, v129
    v_exp_f32 v130, v130
    v_exp_f32 v131, v131
    v_cvt_pk_bf16_f32 v144, v128, v129
    v_cvt_pk_bf16_f32 v145, v130, v131
    v_mfma_f32_32x32x16_bf16 v[112:127], v[196:199], v[36:39], v[112:127]
    buffer_load_dwordx4 v[180:183], v153, s[16:19], s31 offen sc1
    v_exp_f32 v132, v132
    v_exp_f32 v133, v133
    v_exp_f32 v134, v134
    v_exp_f32 v135, v135
    v_cvt_pk_bf16_f32 v146, v132, v133
    v_cvt_pk_bf16_f32 v147, v134, v135
    v_mfma_f32_32x32x16_bf16 v[48:63], v[204:207], v[148:151], v[48:63]
    v_exp_f32 v136, v136
    v_exp_f32 v137, v137
    v_exp_f32 v138, v138
    v_exp_f32 v139, v139
    v_cvt_pk_bf16_f32 v148, v136, v137
    v_cvt_pk_bf16_f32 v149, v138, v139
    v_mfma_f32_32x32x16_bf16 v[64:79], v[200:203], v[144:147], v[64:79]
    s_mov_b64 exec, s[50:51]
    buffer_load_dwordx4 v[184:187], v154, s[16:19], s31 offen sc1
    buffer_load_dwordx4 v[188:191], v155, s[16:19], s31 offen sc1
    s_mov_b64 exec, -1
    s_add_u32 s31, s31, 57344
    v_exp_f32 v140, v140
    v_exp_f32 v141, v141
    v_exp_f32 v142, v142
    v_exp_f32 v143, v143
    v_cvt_pk_bf16_f32 v150, v140, v141
    v_cvt_pk_bf16_f32 v151, v142, v143
    v_mfma_f32_32x32x16_bf16 v[128:143], v[192:195], v[40:43], 0
    v_exp_f32 v112, v112
    v_exp_f32 v113, v113
    v_exp_f32 v114, v114
    v_exp_f32 v115, v115
    v_cvt_pk_bf16_f32 v144, v112, v113
    v_cvt_pk_bf16_f32 v145, v114, v115
    v_mfma_f32_32x32x16_bf16 v[128:143], v[196:199], v[44:47], v[128:143]
    v_exp_f32 v116, v116
    v_exp_f32 v117, v117
    v_exp_f32 v118, v118
    v_exp_f32 v119, v119
    v_cvt_pk_bf16_f32 v146, v116, v117
    v_cvt_pk_bf16_f32 v147, v118, v119
    v_mfma_f32_32x32x16_bf16 v[64:79], v[204:207], v[148:151], v[64:79]
    v_exp_f32 v120, v120
    v_exp_f32 v121, v121
    v_exp_f32 v122, v122
    v_exp_f32 v123, v123
    v_cvt_pk_bf16_f32 v148, v120, v121
    v_cvt_pk_bf16_f32 v149, v122, v123
    v_mfma_f32_32x32x16_bf16 v[80:95], v[200:203], v[144:147], v[80:95]
    v_exp_f32 v124, v124
    v_exp_f32 v125, v125
    v_exp_f32 v126, v126
    v_exp_f32 v127, v127
    v_cvt_pk_bf16_f32 v150, v124, v125
    v_cvt_pk_bf16_f32 v151, v126, v127
    s_waitcnt vmcnt(16)
    v_mfma_f32_32x32x16_bf16 v[112:127], v[208:211], v[16:19], 0
    v_cndmask_b32 v214, v214, v156, s[48:49]
    v_exp_f32 v128, v128
    v_exp_f32 v129, v129
    v_exp_f32 v130, v130
    v_exp_f32 v131, v131
    v_cvt_pk_bf16_f32 v144, v128, v129
    v_cvt_pk_bf16_f32 v145, v130, v131
    v_mfma_f32_32x32x16_bf16 v[112:127], v[212:215], v[20:23], v[112:127]
    v_exp_f32 v132, v132
    v_exp_f32 v133, v133
    v_exp_f32 v134, v134
    v_exp_f32 v135, v135
    v_cvt_pk_bf16_f32 v146, v132, v133
    v_cvt_pk_bf16_f32 v147, v134, v135
    v_mfma_f32_32x32x16_bf16 v[80:95], v[204:207], v[148:151], v[80:95]
    v_exp_f32 v136, v136
    v_exp_f32 v137, v137
    v_exp_f32 v138, v138
    v_exp_f32 v139, v139
    v_cvt_pk_bf16_f32 v148, v136, v137
    v_cvt_pk_bf16_f32 v149, v138, v139
    v_mfma_f32_32x32x16_bf16 v[96:111], v[200:203], v[144:147], v[96:111]
    v_exp_f32 v140, v140
    v_exp_f32 v141, v141
    v_exp_f32 v142, v142
    v_exp_f32 v143, v143
    v_cvt_pk_bf16_f32 v150, v140, v141
    v_cvt_pk_bf16_f32 v151, v142, v143
    v_mfma_f32_32x32x16_bf16 v[128:143], v[208:211], v[24:27], 0
    v_exp_f32 v112, v112
    v_exp_f32 v113, v113
    v_exp_f32 v114, v114
    v_exp_f32 v115, v115
    v_cvt_pk_bf16_f32 v144, v112, v113
    v_cvt_pk_bf16_f32 v145, v114, v115
    v_mfma_f32_32x32x16_bf16 v[128:143], v[212:215], v[28:31], v[128:143]
    v_exp_f32 v116, v116
    v_exp_f32 v117, v117
    v_exp_f32 v118, v118
    v_exp_f32 v119, v119
    v_cvt_pk_bf16_f32 v146, v116, v117
    v_cvt_pk_bf16_f32 v147, v118, v119
    v_mfma_f32_32x32x16_bf16 v[96:111], v[204:207], v[148:151], v[96:111]
    v_exp_f32 v120, v120
    v_exp_f32 v121, v121
    v_exp_f32 v122, v122
    v_exp_f32 v123, v123
    v_cvt_pk_bf16_f32 v148, v120, v121
    v_cvt_pk_bf16_f32 v149, v122, v123
    v_mfma_f32_32x32x16_bf16 v[48:63], v[216:219], v[144:147], v[48:63]
    v_exp_f32 v124, v124
    v_exp_f32 v125, v125
    v_exp_f32 v126, v126
    v_exp_f32 v127, v127
    v_cvt_pk_bf16_f32 v150, v124, v125
    v_cvt_pk_bf16_f32 v151, v126, v127
    v_mfma_f32_32x32x16_bf16 v[112:127], v[208:211], v[32:35], 0
    buffer_load_dwordx4 v[192:195], v152, s[16:19], s31 offen sc1
    v_exp_f32 v128, v128
    v_exp_f32 v129, v129
    v_exp_f32 v130, v130
    v_exp_f32 v131, v131
    v_cvt_pk_bf16_f32 v144, v128, v129
    v_cvt_pk_bf16_f32 v145, v130, v131
    v_mfma_f32_32x32x16_bf16 v[112:127], v[212:215], v[36:39], v[112:127]
    buffer_load_dwordx4 v[196:199], v153, s[16:19], s31 offen sc1
    v_exp_f32 v132, v132
    v_exp_f32 v133, v133
    v_exp_f32 v134, v134
    v_exp_f32 v135, v135
    v_cvt_pk_bf16_f32 v146, v132, v133
    v_cvt_pk_bf16_f32 v147, v134, v135
    v_mfma_f32_32x32x16_bf16 v[48:63], v[220:223], v[148:151], v[48:63]
    v_exp_f32 v136, v136
    v_exp_f32 v137, v137
    v_exp_f32 v138, v138
    v_exp_f32 v139, v139
    v_cvt_pk_bf16_f32 v148, v136, v137
    v_cvt_pk_bf16_f32 v149, v138, v139
    v_mfma_f32_32x32x16_bf16 v[64:79], v[216:219], v[144:147], v[64:79]
    s_mov_b64 exec, s[50:51]
    buffer_load_dwordx4 v[200:203], v154, s[16:19], s31 offen sc1
    buffer_load_dwordx4 v[204:207], v155, s[16:19], s31 offen sc1
    s_mov_b64 exec, -1
    s_add_u32 s31, s31, 57344
    v_exp_f32 v140, v140
    v_exp_f32 v141, v141
    v_exp_f32 v142, v142
    v_exp_f32 v143, v143
    v_cvt_pk_bf16_f32 v150, v140, v141
    v_cvt_pk_bf16_f32 v151, v142, v143
    v_mfma_f32_32x32x16_bf16 v[128:143], v[208:211], v[40:43], 0
    v_exp_f32 v112, v112
    v_exp_f32 v113, v113
    v_exp_f32 v114, v114
    v_exp_f32 v115, v115
    v_cvt_pk_bf16_f32 v144, v112, v113
    v_cvt_pk_bf16_f32 v145, v114, v115
    v_mfma_f32_32x32x16_bf16 v[128:143], v[212:215], v[44:47], v[128:143]
    v_exp_f32 v116, v116
    v_exp_f32 v117, v117
    v_exp_f32 v118, v118
    v_exp_f32 v119, v119
    v_cvt_pk_bf16_f32 v146, v116, v117
    v_cvt_pk_bf16_f32 v147, v118, v119
    v_mfma_f32_32x32x16_bf16 v[64:79], v[220:223], v[148:151], v[64:79]
    v_exp_f32 v120, v120
    v_exp_f32 v121, v121
    v_exp_f32 v122, v122
    v_exp_f32 v123, v123
    v_cvt_pk_bf16_f32 v148, v120, v121
    v_cvt_pk_bf16_f32 v149, v122, v123
    v_mfma_f32_32x32x16_bf16 v[80:95], v[216:219], v[144:147], v[80:95]
    v_exp_f32 v124, v124
    v_exp_f32 v125, v125
    v_exp_f32 v126, v126
    v_exp_f32 v127, v127
    v_cvt_pk_bf16_f32 v150, v124, v125
    v_cvt_pk_bf16_f32 v151, v126, v127
    s_waitcnt vmcnt(16)
    v_mfma_f32_32x32x16_bf16 v[112:127], v[224:227], v[16:19], 0
    v_cndmask_b32 v230, v230, v156, s[48:49]
    v_exp_f32 v128, v128
    v_exp_f32 v129, v129
    v_exp_f32 v130, v130
    v_exp_f32 v131, v131
    v_cvt_pk_bf16_f32 v144, v128, v129
    v_cvt_pk_bf16_f32 v145, v130, v131
    v_mfma_f32_32x32x16_bf16 v[112:127], v[228:231], v[20:23], v[112:127]
    v_exp_f32 v132, v132
    v_exp_f32 v133, v133
    v_exp_f32 v134, v134
    v_exp_f32 v135, v135
    v_cvt_pk_bf16_f32 v146, v132, v133
    v_cvt_pk_bf16_f32 v147, v134, v135
    v_mfma_f32_32x32x16_bf16 v[80:95], v[220:223], v[148:151], v[80:95]
    v_exp_f32 v136, v136
    v_exp_f32 v137, v137
    v_exp_f32 v138, v138
    v_exp_f32 v139, v139
    v_cvt_pk_bf16_f32 v148, v136, v137
    v_cvt_pk_bf16_f32 v149, v138, v139
    v_mfma_f32_32x32x16_bf16 v[96:111], v[216:219], v[144:147], v[96:111]
    v_exp_f32 v140, v140
    v_exp_f32 v141, v141
    v_exp_f32 v142, v142
    v_exp_f32 v143, v143
    v_cvt_pk_bf16_f32 v150, v140, v141
    v_cvt_pk_bf16_f32 v151, v142, v143
    v_mfma_f32_32x32x16_bf16 v[128:143], v[224:227], v[24:27], 0
    v_exp_f32 v112, v112
    v_exp_f32 v113, v113
    v_exp_f32 v114, v114
    v_exp_f32 v115, v115
    v_cvt_pk_bf16_f32 v144, v112, v113
    v_cvt_pk_bf16_f32 v145, v114, v115
    v_mfma_f32_32x32x16_bf16 v[128:143], v[228:231], v[28:31], v[128:143]
    v_exp_f32 v116, v116
    v_exp_f32 v117, v117
    v_exp_f32 v118, v118
    v_exp_f32 v119, v119
    v_cvt_pk_bf16_f32 v146, v116, v117
    v_cvt_pk_bf16_f32 v147, v118, v119
    v_mfma_f32_32x32x16_bf16 v[96:111], v[220:223], v[148:151], v[96:111]
    v_exp_f32 v120, v120
    v_exp_f32 v121, v121
    v_exp_f32 v122, v122
    v_exp_f32 v123, v123
    v_cvt_pk_bf16_f32 v148, v120, v121
    v_cvt_pk_bf16_f32 v149, v122, v123
    v_mfma_f32_32x32x16_bf16 v[48:63], v[232:235], v[144:147], v[48:63]
    v_exp_f32 v124, v124
    v_exp_f32 v125, v125
    v_exp_f32 v126, v126
    v_exp_f32 v127, v127
    v_cvt_pk_bf16_f32 v150, v124, v125
    v_cvt_pk_bf16_f32 v151, v126, v127
    v_mfma_f32_32x32x16_bf16 v[112:127], v[224:227], v[32:35], 0
    buffer_load_dwordx4 v[208:211], v152, s[16:19], s31 offen sc1
    v_exp_f32 v128, v128
    v_exp_f32 v129, v129
    v_exp_f32 v130, v130
    v_exp_f32 v131, v131
    v_cvt_pk_bf16_f32 v144, v128, v129
    v_cvt_pk_bf16_f32 v145, v130, v131
    v_mfma_f32_32x32x16_bf16 v[112:127], v[228:231], v[36:39], v[112:127]
    buffer_load_dwordx4 v[212:215], v153, s[16:19], s31 offen sc1
    v_exp_f32 v132, v132
    v_exp_f32 v133, v133
    v_exp_f32 v134, v134
    v_exp_f32 v135, v135
    v_cvt_pk_bf16_f32 v146, v132, v133
    v_cvt_pk_bf16_f32 v147, v134, v135
    v_mfma_f32_32x32x16_bf16 v[48:63], v[236:239], v[148:151], v[48:63]
    v_exp_f32 v136, v136
    v_exp_f32 v137, v137
    v_exp_f32 v138, v138
    v_exp_f32 v139, v139
    v_cvt_pk_bf16_f32 v148, v136, v137
    v_cvt_pk_bf16_f32 v149, v138, v139
    v_mfma_f32_32x32x16_bf16 v[64:79], v[232:235], v[144:147], v[64:79]
    s_mov_b64 exec, s[50:51]
    buffer_load_dwordx4 v[216:219], v154, s[16:19], s31 offen sc1
    buffer_load_dwordx4 v[220:223], v155, s[16:19], s31 offen sc1
    s_mov_b64 exec, -1
    s_add_u32 s31, s31, 57344
    v_exp_f32 v140, v140
    v_exp_f32 v141, v141
    v_exp_f32 v142, v142
    v_exp_f32 v143, v143
    v_cvt_pk_bf16_f32 v150, v140, v141
    v_cvt_pk_bf16_f32 v151, v142, v143
    v_mfma_f32_32x32x16_bf16 v[128:143], v[224:227], v[40:43], 0
    v_exp_f32 v112, v112
    v_exp_f32 v113, v113
    v_exp_f32 v114, v114
    v_exp_f32 v115, v115
    v_cvt_pk_bf16_f32 v144, v112, v113
    v_cvt_pk_bf16_f32 v145, v114, v115
    v_mfma_f32_32x32x16_bf16 v[128:143], v[228:231], v[44:47], v[128:143]
    v_exp_f32 v116, v116
    v_exp_f32 v117, v117
    v_exp_f32 v118, v118
    v_exp_f32 v119, v119
    v_cvt_pk_bf16_f32 v146, v116, v117
    v_cvt_pk_bf16_f32 v147, v118, v119
    v_mfma_f32_32x32x16_bf16 v[64:79], v[236:239], v[148:151], v[64:79]
    v_exp_f32 v120, v120
    v_exp_f32 v121, v121
    v_exp_f32 v122, v122
    v_exp_f32 v123, v123
    v_cvt_pk_bf16_f32 v148, v120, v121
    v_cvt_pk_bf16_f32 v149, v122, v123
    v_mfma_f32_32x32x16_bf16 v[80:95], v[232:235], v[144:147], v[80:95]
    v_exp_f32 v124, v124
    v_exp_f32 v125, v125
    v_exp_f32 v126, v126
    v_exp_f32 v127, v127
    v_cvt_pk_bf16_f32 v150, v124, v125
    v_cvt_pk_bf16_f32 v151, v126, v127
    s_waitcnt vmcnt(16)
    v_mfma_f32_32x32x16_bf16 v[112:127], v[240:243], v[16:19], 0
    v_cndmask_b32 v246, v246, v156, s[48:49]
    v_exp_f32 v128, v128
    v_exp_f32 v129, v129
    v_exp_f32 v130, v130
    v_exp_f32 v131, v131
    v_cvt_pk_bf16_f32 v144, v128, v129
    v_cvt_pk_bf16_f32 v145, v130, v131
    v_mfma_f32_32x32x16_bf16 v[112:127], v[244:247], v[20:23], v[112:127]
    v_exp_f32 v132, v132
    v_exp_f32 v133, v133
    v_exp_f32 v134, v134
    v_exp_f32 v135, v135
    v_cvt_pk_bf16_f32 v146, v132, v133
    v_cvt_pk_bf16_f32 v147, v134, v135
    v_mfma_f32_32x32x16_bf16 v[80:95], v[236:239], v[148:151], v[80:95]
    v_exp_f32 v136, v136
    v_exp_f32 v137, v137
    v_exp_f32 v138, v138
    v_exp_f32 v139, v139
    v_cvt_pk_bf16_f32 v148, v136, v137
    v_cvt_pk_bf16_f32 v149, v138, v139
    v_mfma_f32_32x32x16_bf16 v[96:111], v[232:235], v[144:147], v[96:111]
    v_exp_f32 v140, v140
    v_exp_f32 v141, v141
    v_exp_f32 v142, v142
    v_exp_f32 v143, v143
    v_cvt_pk_bf16_f32 v150, v140, v141
    v_cvt_pk_bf16_f32 v151, v142, v143
    v_mfma_f32_32x32x16_bf16 v[128:143], v[240:243], v[24:27], 0
    v_exp_f32 v112, v112
    v_exp_f32 v113, v113
    v_exp_f32 v114, v114
    v_exp_f32 v115, v115
    v_cvt_pk_bf16_f32 v144, v112, v113
    v_cvt_pk_bf16_f32 v145, v114, v115
    v_mfma_f32_32x32x16_bf16 v[128:143], v[244:247], v[28:31], v[128:143]
    v_exp_f32 v116, v116
    v_exp_f32 v117, v117
    v_exp_f32 v118, v118
    v_exp_f32 v119, v119
    v_cvt_pk_bf16_f32 v146, v116, v117
    v_cvt_pk_bf16_f32 v147, v118, v119
    v_mfma_f32_32x32x16_bf16 v[96:111], v[236:239], v[148:151], v[96:111]
    v_exp_f32 v120, v120
    v_exp_f32 v121, v121
    v_exp_f32 v122, v122
    v_exp_f32 v123, v123
    v_cvt_pk_bf16_f32 v148, v120, v121
    v_cvt_pk_bf16_f32 v149, v122, v123
    v_mfma_f32_32x32x16_bf16 v[48:63], v[248:251], v[144:147], v[48:63]
    v_exp_f32 v124, v124
    v_exp_f32 v125, v125
    v_exp_f32 v126, v126
    v_exp_f32 v127, v127
    v_cvt_pk_bf16_f32 v150, v124, v125
    v_cvt_pk_bf16_f32 v151, v126, v127
    v_mfma_f32_32x32x16_bf16 v[112:127], v[240:243], v[32:35], 0
    v_exp_f32 v128, v128
    v_exp_f32 v129, v129
    v_exp_f32 v130, v130
    v_exp_f32 v131, v131
    v_cvt_pk_bf16_f32 v144, v128, v129
    v_cvt_pk_bf16_f32 v145, v130, v131
    v_mfma_f32_32x32x16_bf16 v[112:127], v[244:247], v[36:39], v[112:127]
    v_exp_f32 v132, v132
    v_exp_f32 v133, v133
    v_exp_f32 v134, v134
    v_exp_f32 v135, v135
    v_cvt_pk_bf16_f32 v146, v132, v133
    v_cvt_pk_bf16_f32 v147, v134, v135
    v_mfma_f32_32x32x16_bf16 v[48:63], v[252:255], v[148:151], v[48:63]
    v_exp_f32 v136, v136
    v_exp_f32 v137, v137
    v_exp_f32 v138, v138
    v_exp_f32 v139, v139
    v_cvt_pk_bf16_f32 v148, v136, v137
    v_cvt_pk_bf16_f32 v149, v138, v139
    v_mfma_f32_32x32x16_bf16 v[64:79], v[248:251], v[144:147], v[64:79]
    v_exp_f32 v140, v140
    v_exp_f32 v141, v141
    v_exp_f32 v142, v142
    v_exp_f32 v143, v143
    v_cvt_pk_bf16_f32 v150, v140, v141
    v_cvt_pk_bf16_f32 v151, v142, v143
    v_mfma_f32_32x32x16_bf16 v[128:143], v[240:243], v[40:43], 0
    v_exp_f32 v112, v112
    v_exp_f32 v113, v113
    v_exp_f32 v114, v114
    v_exp_f32 v115, v115
    v_cvt_pk_bf16_f32 v144, v112, v113
    v_cvt_pk_bf16_f32 v145, v114, v115
    v_mfma_f32_32x32x16_bf16 v[128:143], v[244:247], v[44:47], v[128:143]
    v_exp_f32 v116, v116
    v_exp_f32 v117, v117
    v_exp_f32 v118, v118
    v_exp_f32 v119, v119
    v_cvt_pk_bf16_f32 v146, v116, v117
    v_cvt_pk_bf16_f32 v147, v118, v119
    v_mfma_f32_32x32x16_bf16 v[64:79], v[252:255], v[148:151], v[64:79]
    v_exp_f32 v120, v120
    v_exp_f32 v121, v121
    v_exp_f32 v122, v122
    v_exp_f32 v123, v123
    v_cvt_pk_bf16_f32 v148, v120, v121
    v_cvt_pk_bf16_f32 v149, v122, v123
    v_mfma_f32_32x32x16_bf16 v[80:95], v[248:251], v[144:147], v[80:95]
    v_exp_f32 v124, v124
    v_exp_f32 v125, v125
    v_exp_f32 v126, v126
    v_exp_f32 v127, v127
    v_cvt_pk_bf16_f32 v150, v124, v125
    v_cvt_pk_bf16_f32 v151, v126, v127
    s_waitcnt vmcnt(12)
    v_mfma_f32_32x32x16_bf16 v[112:127], v[160:163], v[24:27], 0
    v_cndmask_b32 v166, v166, v156, s[48:49]
    v_exp_f32 v128, v128
    v_exp_f32 v129, v129
    v_exp_f32 v130, v130
    v_exp_f32 v131, v131
    v_cvt_pk_bf16_f32 v144, v128, v129
    v_cvt_pk_bf16_f32 v145, v130, v131
    v_mfma_f32_32x32x16_bf16 v[112:127], v[164:167], v[28:31], v[112:127]
    v_exp_f32 v132, v132
    v_exp_f32 v133, v133
    v_exp_f32 v134, v134
    v_exp_f32 v135, v135
    v_cvt_pk_bf16_f32 v146, v132, v133
    v_cvt_pk_bf16_f32 v147, v134, v135
    v_mfma_f32_32x32x16_bf16 v[80:95], v[252:255], v[148:151], v[80:95]
    v_exp_f32 v136, v136
    v_exp_f32 v137, v137
    v_exp_f32 v138, v138
    v_exp_f32 v139, v139
    v_cvt_pk_bf16_f32 v148, v136, v137
    v_cvt_pk_bf16_f32 v149, v138, v139
    v_mfma_f32_32x32x16_bf16 v[96:111], v[248:251], v[144:147], v[96:111]
    v_exp_f32 v140, v140
    v_exp_f32 v141, v141
    v_exp_f32 v142, v142
    v_exp_f32 v143, v143
    v_cvt_pk_bf16_f32 v150, v140, v141
    v_cvt_pk_bf16_f32 v151, v142, v143
    s_waitcnt vmcnt(8)
    v_mfma_f32_32x32x16_bf16 v[128:143], v[176:179], v[24:27], 0
    v_cndmask_b32 v182, v182, v156, s[48:49]
    v_exp_f32 v112, v112
    v_exp_f32 v113, v113
    v_exp_f32 v114, v114
    v_exp_f32 v115, v115
    v_cvt_pk_bf16_f32 v144, v112, v113
    v_cvt_pk_bf16_f32 v145, v114, v115
    v_mfma_f32_32x32x16_bf16 v[128:143], v[180:183], v[28:31], v[128:143]
    v_exp_f32 v116, v116
    v_exp_f32 v117, v117
    v_exp_f32 v118, v118
    v_exp_f32 v119, v119
    v_cvt_pk_bf16_f32 v146, v116, v117
    v_cvt_pk_bf16_f32 v147, v118, v119
    v_mfma_f32_32x32x16_bf16 v[96:111], v[252:255], v[148:151], v[96:111]
    v_exp_f32 v120, v120
    v_exp_f32 v121, v121
    v_exp_f32 v122, v122
    v_exp_f32 v123, v123
    v_cvt_pk_bf16_f32 v148, v120, v121
    v_cvt_pk_bf16_f32 v149, v122, v123
    v_mfma_f32_32x32x16_bf16 v[64:79], v[168:171], v[144:147], v[64:79]
    v_exp_f32 v124, v124
    v_exp_f32 v125, v125
    v_exp_f32 v126, v126
    v_exp_f32 v127, v127
    v_cvt_pk_bf16_f32 v150, v124, v125
    v_cvt_pk_bf16_f32 v151, v126, v127
    s_waitcnt vmcnt(4)
    v_mfma_f32_32x32x16_bf16 v[112:127], v[192:195], v[24:27], 0
    v_cndmask_b32 v198, v198, v156, s[48:49]
    v_exp_f32 v128, v128
    v_exp_f32 v129, v129
    v_exp_f32 v130, v130
    v_exp_f32 v131, v131
    v_cvt_pk_bf16_f32 v144, v128, v129
    v_cvt_pk_bf16_f32 v145, v130, v131
    v_mfma_f32_32x32x16_bf16 v[112:127], v[196:199], v[28:31], v[112:127]
    v_exp_f32 v132, v132
    v_exp_f32 v133, v133
    v_exp_f32 v134, v134
    v_exp_f32 v135, v135
    v_cvt_pk_bf16_f32 v146, v132, v133
    v_cvt_pk_bf16_f32 v147, v134, v135
    v_mfma_f32_32x32x16_bf16 v[64:79], v[172:175], v[148:151], v[64:79]
    v_exp_f32 v136, v136
    v_exp_f32 v137, v137
    v_exp_f32 v138, v138
    v_exp_f32 v139, v139
    v_cvt_pk_bf16_f32 v148, v136, v137
    v_cvt_pk_bf16_f32 v149, v138, v139
    v_mfma_f32_32x32x16_bf16 v[64:79], v[184:187], v[144:147], v[64:79]
    v_exp_f32 v140, v140
    v_exp_f32 v141, v141
    v_exp_f32 v142, v142
    v_exp_f32 v143, v143
    v_cvt_pk_bf16_f32 v150, v140, v141
    v_cvt_pk_bf16_f32 v151, v142, v143
    s_waitcnt vmcnt(0)
    v_mfma_f32_32x32x16_bf16 v[128:143], v[208:211], v[24:27], 0
    v_cndmask_b32 v214, v214, v156, s[48:49]
    v_exp_f32 v112, v112
    v_exp_f32 v113, v113
    v_exp_f32 v114, v114
    v_exp_f32 v115, v115
    v_cvt_pk_bf16_f32 v144, v112, v113
    v_cvt_pk_bf16_f32 v145, v114, v115
    v_mfma_f32_32x32x16_bf16 v[128:143], v[212:215], v[28:31], v[128:143]
    v_exp_f32 v116, v116
    v_exp_f32 v117, v117
    v_exp_f32 v118, v118
    v_exp_f32 v119, v119
    v_cvt_pk_bf16_f32 v146, v116, v117
    v_cvt_pk_bf16_f32 v147, v118, v119
    v_mfma_f32_32x32x16_bf16 v[64:79], v[188:191], v[148:151], v[64:79]
    v_exp_f32 v120, v120
    v_exp_f32 v121, v121
    v_exp_f32 v122, v122
    v_exp_f32 v123, v123
    v_cvt_pk_bf16_f32 v148, v120, v121
    v_cvt_pk_bf16_f32 v149, v122, v123
    v_mfma_f32_32x32x16_bf16 v[64:79], v[200:203], v[144:147], v[64:79]
    v_exp_f32 v124, v124
    v_exp_f32 v125, v125
    v_exp_f32 v126, v126
    v_exp_f32 v127, v127
    v_cvt_pk_bf16_f32 v150, v124, v125
    v_cvt_pk_bf16_f32 v151, v126, v127
    v_mfma_f32_32x32x16_bf16 v[112:127], v[160:163], v[32:35], 0
    v_exp_f32 v128, v128
    v_exp_f32 v129, v129
    v_exp_f32 v130, v130
    v_exp_f32 v131, v131
    v_cvt_pk_bf16_f32 v144, v128, v129
    v_cvt_pk_bf16_f32 v145, v130, v131
    v_mfma_f32_32x32x16_bf16 v[112:127], v[164:167], v[36:39], v[112:127]
    v_exp_f32 v132, v132
    v_exp_f32 v133, v133
    v_exp_f32 v134, v134
    v_exp_f32 v135, v135
    v_cvt_pk_bf16_f32 v146, v132, v133
    v_cvt_pk_bf16_f32 v147, v134, v135
    v_mfma_f32_32x32x16_bf16 v[64:79], v[204:207], v[148:151], v[64:79]
    v_exp_f32 v136, v136
    v_exp_f32 v137, v137
    v_exp_f32 v138, v138
    v_exp_f32 v139, v139
    v_cvt_pk_bf16_f32 v148, v136, v137
    v_cvt_pk_bf16_f32 v149, v138, v139
    v_mfma_f32_32x32x16_bf16 v[64:79], v[216:219], v[144:147], v[64:79]
    v_exp_f32 v140, v140
    v_exp_f32 v141, v141
    v_exp_f32 v142, v142
    v_exp_f32 v143, v143
    v_cvt_pk_bf16_f32 v150, v140, v141
    v_cvt_pk_bf16_f32 v151, v142, v143
    v_mfma_f32_32x32x16_bf16 v[128:143], v[176:179], v[32:35], 0
    v_exp_f32 v112, v112
    v_exp_f32 v113, v113
    v_exp_f32 v114, v114
    v_exp_f32 v115, v115
    v_cvt_pk_bf16_f32 v144, v112, v113
    v_cvt_pk_bf16_f32 v145, v114, v115
    v_mfma_f32_32x32x16_bf16 v[128:143], v[180:183], v[36:39], v[128:143]
    v_exp_f32 v116, v116
    v_exp_f32 v117, v117
    v_exp_f32 v118, v118
    v_exp_f32 v119, v119
    v_cvt_pk_bf16_f32 v146, v116, v117
    v_cvt_pk_bf16_f32 v147, v118, v119
    v_mfma_f32_32x32x16_bf16 v[64:79], v[220:223], v[148:151], v[64:79]
    v_exp_f32 v120, v120
    v_exp_f32 v121, v121
    v_exp_f32 v122, v122
    v_exp_f32 v123, v123
    v_cvt_pk_bf16_f32 v148, v120, v121
    v_cvt_pk_bf16_f32 v149, v122, v123
    v_mfma_f32_32x32x16_bf16 v[80:95], v[168:171], v[144:147], v[80:95]
    v_exp_f32 v124, v124
    v_exp_f32 v125, v125
    v_exp_f32 v126, v126
    v_exp_f32 v127, v127
    v_cvt_pk_bf16_f32 v150, v124, v125
    v_cvt_pk_bf16_f32 v151, v126, v127
    v_mfma_f32_32x32x16_bf16 v[112:127], v[192:195], v[32:35], 0
    ds_write_b128 v13, v[64:67] offset:0
    v_exp_f32 v128, v128
    v_exp_f32 v129, v129
    v_exp_f32 v130, v130
    v_exp_f32 v131, v131
    v_cvt_pk_bf16_f32 v144, v128, v129
    v_cvt_pk_bf16_f32 v145, v130, v131
    v_mfma_f32_32x32x16_bf16 v[112:127], v[196:199], v[36:39], v[112:127]
    ds_write_b128 v13, v[68:71] offset:1024
    v_exp_f32 v132, v132
    v_exp_f32 v133, v133
    v_exp_f32 v134, v134
    v_exp_f32 v135, v135
    v_cvt_pk_bf16_f32 v146, v132, v133
    v_cvt_pk_bf16_f32 v147, v134, v135
    v_mfma_f32_32x32x16_bf16 v[80:95], v[172:175], v[148:151], v[80:95]
    ds_write_b128 v13, v[72:75] offset:2048
    v_exp_f32 v136, v136
    v_exp_f32 v137, v137
    v_exp_f32 v138, v138
    v_exp_f32 v139, v139
    v_cvt_pk_bf16_f32 v148, v136, v137
    v_cvt_pk_bf16_f32 v149, v138, v139
    v_mfma_f32_32x32x16_bf16 v[80:95], v[184:187], v[144:147], v[80:95]
    ds_write_b128 v13, v[76:79] offset:3072
    v_exp_f32 v140, v140
    v_exp_f32 v141, v141
    v_exp_f32 v142, v142
    v_exp_f32 v143, v143
    v_cvt_pk_bf16_f32 v150, v140, v141
    v_cvt_pk_bf16_f32 v151, v142, v143
    v_mfma_f32_32x32x16_bf16 v[128:143], v[208:211], v[32:35], 0
    v_exp_f32 v112, v112
    v_exp_f32 v113, v113
    v_exp_f32 v114, v114
    v_exp_f32 v115, v115
    v_cvt_pk_bf16_f32 v144, v112, v113
    v_cvt_pk_bf16_f32 v145, v114, v115
    v_mfma_f32_32x32x16_bf16 v[128:143], v[212:215], v[36:39], v[128:143]
    v_exp_f32 v116, v116
    v_exp_f32 v117, v117
    v_exp_f32 v118, v118
    v_exp_f32 v119, v119
    v_cvt_pk_bf16_f32 v146, v116, v117
    v_cvt_pk_bf16_f32 v147, v118, v119
    v_mfma_f32_32x32x16_bf16 v[80:95], v[188:191], v[148:151], v[80:95]
    v_exp_f32 v120, v120
    v_exp_f32 v121, v121
    v_exp_f32 v122, v122
    v_exp_f32 v123, v123
    v_cvt_pk_bf16_f32 v148, v120, v121
    v_cvt_pk_bf16_f32 v149, v122, v123
    v_mfma_f32_32x32x16_bf16 v[80:95], v[200:203], v[144:147], v[80:95]
    v_exp_f32 v124, v124
    v_exp_f32 v125, v125
    v_exp_f32 v126, v126
    v_exp_f32 v127, v127
    v_cvt_pk_bf16_f32 v150, v124, v125
    v_cvt_pk_bf16_f32 v151, v126, v127
    v_mfma_f32_32x32x16_bf16 v[112:127], v[160:163], v[40:43], 0
    v_exp_f32 v128, v128
    v_exp_f32 v129, v129
    v_exp_f32 v130, v130
    v_exp_f32 v131, v131
    v_cvt_pk_bf16_f32 v144, v128, v129
    v_cvt_pk_bf16_f32 v145, v130, v131
    v_mfma_f32_32x32x16_bf16 v[112:127], v[164:167], v[44:47], v[112:127]
    v_exp_f32 v132, v132
    v_exp_f32 v133, v133
    v_exp_f32 v134, v134
    v_exp_f32 v135, v135
    v_cvt_pk_bf16_f32 v146, v132, v133
    v_cvt_pk_bf16_f32 v147, v134, v135
    v_mfma_f32_32x32x16_bf16 v[80:95], v[204:207], v[148:151], v[80:95]
    v_exp_f32 v136, v136
    v_exp_f32 v137, v137
    v_exp_f32 v138, v138
    v_exp_f32 v139, v139
    v_cvt_pk_bf16_f32 v148, v136, v137
    v_cvt_pk_bf16_f32 v149, v138, v139
    v_mfma_f32_32x32x16_bf16 v[80:95], v[216:219], v[144:147], v[80:95]
    v_exp_f32 v140, v140
    v_exp_f32 v141, v141
    v_exp_f32 v142, v142
    v_exp_f32 v143, v143
    v_cvt_pk_bf16_f32 v150, v140, v141
    v_cvt_pk_bf16_f32 v151, v142, v143
    v_mfma_f32_32x32x16_bf16 v[128:143], v[176:179], v[40:43], 0
    v_exp_f32 v112, v112
    v_exp_f32 v113, v113
    v_exp_f32 v114, v114
    v_exp_f32 v115, v115
    v_cvt_pk_bf16_f32 v144, v112, v113
    v_cvt_pk_bf16_f32 v145, v114, v115
    v_mfma_f32_32x32x16_bf16 v[128:143], v[180:183], v[44:47], v[128:143]
    v_exp_f32 v116, v116
    v_exp_f32 v117, v117
    v_exp_f32 v118, v118
    v_exp_f32 v119, v119
    v_cvt_pk_bf16_f32 v146, v116, v117
    v_cvt_pk_bf16_f32 v147, v118, v119
    v_mfma_f32_32x32x16_bf16 v[80:95], v[220:223], v[148:151], v[80:95]
    v_exp_f32 v120, v120
    v_exp_f32 v121, v121
    v_exp_f32 v122, v122
    v_exp_f32 v123, v123
    v_cvt_pk_bf16_f32 v148, v120, v121
    v_cvt_pk_bf16_f32 v149, v122, v123
    v_mfma_f32_32x32x16_bf16 v[96:111], v[168:171], v[144:147], v[96:111]
    v_exp_f32 v124, v124
    v_exp_f32 v125, v125
    v_exp_f32 v126, v126
    v_exp_f32 v127, v127
    v_cvt_pk_bf16_f32 v150, v124, v125
    v_cvt_pk_bf16_f32 v151, v126, v127
    v_mfma_f32_32x32x16_bf16 v[112:127], v[192:195], v[40:43], 0
    ds_write_b128 v14, v[80:83] offset:0
    v_exp_f32 v128, v128
    v_exp_f32 v129, v129
    v_exp_f32 v130, v130
    v_exp_f32 v131, v131
    v_cvt_pk_bf16_f32 v144, v128, v129
    v_cvt_pk_bf16_f32 v145, v130, v131
    v_mfma_f32_32x32x16_bf16 v[112:127], v[196:199], v[44:47], v[112:127]
    ds_write_b128 v14, v[84:87] offset:1024
    v_exp_f32 v132, v132
    v_exp_f32 v133, v133
    v_exp_f32 v134, v134
    v_exp_f32 v135, v135
    v_cvt_pk_bf16_f32 v146, v132, v133
    v_cvt_pk_bf16_f32 v147, v134, v135
    v_mfma_f32_32x32x16_bf16 v[96:111], v[172:175], v[148:151], v[96:111]
    ds_write_b128 v14, v[88:91] offset:2048
    v_exp_f32 v136, v136
    v_exp_f32 v137, v137
    v_exp_f32 v138, v138
    v_exp_f32 v139, v139
    v_cvt_pk_bf16_f32 v148, v136, v137
    v_cvt_pk_bf16_f32 v149, v138, v139
    v_mfma_f32_32x32x16_bf16 v[96:111], v[184:187], v[144:147], v[96:111]
    ds_write_b128 v14, v[92:95] offset:3072
    v_exp_f32 v140, v140
    v_exp_f32 v141, v141
    v_exp_f32 v142, v142
    v_exp_f32 v143, v143
    v_cvt_pk_bf16_f32 v150, v140, v141
    v_cvt_pk_bf16_f32 v151, v142, v143
    v_mfma_f32_32x32x16_bf16 v[128:143], v[208:211], v[40:43], 0
    v_exp_f32 v112, v112
    v_exp_f32 v113, v113
    v_exp_f32 v114, v114
    v_exp_f32 v115, v115
    v_cvt_pk_bf16_f32 v144, v112, v113
    v_cvt_pk_bf16_f32 v145, v114, v115
    v_mfma_f32_32x32x16_bf16 v[128:143], v[212:215], v[44:47], v[128:143]
    v_exp_f32 v116, v116
    v_exp_f32 v117, v117
    v_exp_f32 v118, v118
    v_exp_f32 v119, v119
    v_cvt_pk_bf16_f32 v146, v116, v117
    v_cvt_pk_bf16_f32 v147, v118, v119
    v_mfma_f32_32x32x16_bf16 v[96:111], v[188:191], v[148:151], v[96:111]
    v_exp_f32 v120, v120
    v_exp_f32 v121, v121
    v_exp_f32 v122, v122
    v_exp_f32 v123, v123
    v_cvt_pk_bf16_f32 v148, v120, v121
    v_cvt_pk_bf16_f32 v149, v122, v123
    v_mfma_f32_32x32x16_bf16 v[96:111], v[200:203], v[144:147], v[96:111]
    v_exp_f32 v124, v124
    v_exp_f32 v125, v125
    v_exp_f32 v126, v126
    v_exp_f32 v127, v127
    v_cvt_pk_bf16_f32 v150, v124, v125
    v_cvt_pk_bf16_f32 v151, v126, v127
    v_mfma_f32_32x32x16_bf16 v[112:127], v[160:163], v[16:19], 0
    v_exp_f32 v128, v128
    v_exp_f32 v129, v129
    v_exp_f32 v130, v130
    v_exp_f32 v131, v131
    v_cvt_pk_bf16_f32 v144, v128, v129
    v_cvt_pk_bf16_f32 v145, v130, v131
    v_mfma_f32_32x32x16_bf16 v[112:127], v[164:167], v[20:23], v[112:127]
    v_exp_f32 v132, v132
    v_exp_f32 v133, v133
    v_exp_f32 v134, v134
    v_exp_f32 v135, v135
    v_cvt_pk_bf16_f32 v146, v132, v133
    v_cvt_pk_bf16_f32 v147, v134, v135
    v_mfma_f32_32x32x16_bf16 v[96:111], v[204:207], v[148:151], v[96:111]
    v_exp_f32 v136, v136
    v_exp_f32 v137, v137
    v_exp_f32 v138, v138
    v_exp_f32 v139, v139
    v_cvt_pk_bf16_f32 v148, v136, v137
    v_cvt_pk_bf16_f32 v149, v138, v139
    v_mfma_f32_32x32x16_bf16 v[96:111], v[216:219], v[144:147], v[96:111]
    v_exp_f32 v140, v140
    v_exp_f32 v141, v141
    v_exp_f32 v142, v142
    v_exp_f32 v143, v143
    v_cvt_pk_bf16_f32 v150, v140, v141
    v_cvt_pk_bf16_f32 v151, v142, v143
    v_mfma_f32_32x32x16_bf16 v[128:143], v[176:179], v[16:19], 0
    v_exp_f32 v112, v112
    v_exp_f32 v113, v113
    v_exp_f32 v114, v114
    v_exp_f32 v115, v115
    v_cvt_pk_bf16_f32 v144, v112, v113
    v_cvt_pk_bf16_f32 v145, v114, v115
    v_mfma_f32_32x32x16_bf16 v[128:143], v[180:183], v[20:23], v[128:143]
    v_exp_f32 v116, v116
    v_exp_f32 v117, v117
    v_exp_f32 v118, v118
    v_exp_f32 v119, v119
    v_cvt_pk_bf16_f32 v146, v116, v117
    v_cvt_pk_bf16_f32 v147, v118, v119
    v_mfma_f32_32x32x16_bf16 v[96:111], v[220:223], v[148:151], v[96:111]
    v_exp_f32 v120, v120
    v_exp_f32 v121, v121
    v_exp_f32 v122, v122
    v_exp_f32 v123, v123
    v_cvt_pk_bf16_f32 v148, v120, v121
    v_cvt_pk_bf16_f32 v149, v122, v123
    v_mfma_f32_32x32x16_bf16 v[48:63], v[168:171], v[144:147], v[48:63]
    v_exp_f32 v124, v124
    v_exp_f32 v125, v125
    v_exp_f32 v126, v126
    v_exp_f32 v127, v127
    v_cvt_pk_bf16_f32 v150, v124, v125
    v_cvt_pk_bf16_f32 v151, v126, v127
    v_mfma_f32_32x32x16_bf16 v[112:127], v[192:195], v[16:19], 0
    ds_write_b128 v15, v[96:99] offset:0
    v_exp_f32 v128, v128
    v_exp_f32 v129, v129
    v_exp_f32 v130, v130
    v_exp_f32 v131, v131
    v_cvt_pk_bf16_f32 v144, v128, v129
    v_cvt_pk_bf16_f32 v145, v130, v131
    v_mfma_f32_32x32x16_bf16 v[112:127], v[196:199], v[20:23], v[112:127]
    ds_write_b128 v15, v[100:103] offset:1024
    v_exp_f32 v132, v132
    v_exp_f32 v133, v133
    v_exp_f32 v134, v134
    v_exp_f32 v135, v135
    v_cvt_pk_bf16_f32 v146, v132, v133
    v_cvt_pk_bf16_f32 v147, v134, v135
    v_mfma_f32_32x32x16_bf16 v[48:63], v[172:175], v[148:151], v[48:63]
    ds_write_b128 v15, v[104:107] offset:2048
    v_exp_f32 v136, v136
    v_exp_f32 v137, v137
    v_exp_f32 v138, v138
    v_exp_f32 v139, v139
    v_cvt_pk_bf16_f32 v148, v136, v137
    v_cvt_pk_bf16_f32 v149, v138, v139
    v_mfma_f32_32x32x16_bf16 v[48:63], v[184:187], v[144:147], v[48:63]
    ds_write_b128 v15, v[108:111] offset:3072
    v_exp_f32 v140, v140
    v_exp_f32 v141, v141
    v_exp_f32 v142, v142
    v_exp_f32 v143, v143
    v_cvt_pk_bf16_f32 v150, v140, v141
    v_cvt_pk_bf16_f32 v151, v142, v143
    v_mfma_f32_32x32x16_bf16 v[128:143], v[208:211], v[16:19], 0
    v_exp_f32 v112, v112
    v_exp_f32 v113, v113
    v_exp_f32 v114, v114
    v_exp_f32 v115, v115
    v_cvt_pk_bf16_f32 v144, v112, v113
    v_cvt_pk_bf16_f32 v145, v114, v115
    v_mfma_f32_32x32x16_bf16 v[128:143], v[212:215], v[20:23], v[128:143]
    s_waitcnt lgkmcnt(0)
    s_mov_b64 exec, 1
    ds_add_u32 v157, v158 offset:44
    s_mov_b64 exec, -1
    v_exp_f32 v116, v116
    v_exp_f32 v117, v117
    v_exp_f32 v118, v118
    v_exp_f32 v119, v119
    v_cvt_pk_bf16_f32 v146, v116, v117
    v_cvt_pk_bf16_f32 v147, v118, v119
    v_mfma_f32_32x32x16_bf16 v[48:63], v[188:191], v[148:151], v[48:63]
    v_exp_f32 v120, v120
    v_exp_f32 v121, v121
    v_exp_f32 v122, v122
    v_exp_f32 v123, v123
    v_cvt_pk_bf16_f32 v148, v120, v121
    v_cvt_pk_bf16_f32 v149, v122, v123
    v_mfma_f32_32x32x16_bf16 v[48:63], v[200:203], v[144:147], v[48:63]
    ds_read_b128 v[8:11], v157 offset:32
    v_exp_f32 v124, v124
    v_exp_f32 v125, v125
    v_exp_f32 v126, v126
    v_exp_f32 v127, v127
    v_cvt_pk_bf16_f32 v150, v124, v125
    v_cvt_pk_bf16_f32 v151, v126, v127
    v_exp_f32 v128, v128
    v_exp_f32 v129, v129
    v_exp_f32 v130, v130
    v_exp_f32 v131, v131
    v_cvt_pk_bf16_f32 v144, v128, v129
    v_cvt_pk_bf16_f32 v145, v130, v131
    s_mov_b32 s33, 200000
m_rsync:
    s_waitcnt lgkmcnt(0)
    v_add_u32 v8, v8, v11
    s_sub_u32 s33, s33, 1
    v_cmp_gt_u32 vcc, 12, v8
    s_cbranch_scc1 m_rsync_ok
    s_cbranch_vccz m_rsync_ok
    ds_read_b128 v[8:11], v157 offset:32
    s_branch m_rsync
m_rsync_ok:
    ds_read_b32 v7, v2
    ds_read_b128 v[64:67], v4 offset:0
    ds_read_b128 v[68:71], v4 offset:1024
    ds_read_b128 v[72:75], v4 offset:2048
    ds_read_b128 v[76:79], v4 offset:3072
    ds_read_b128 v[80:83], v4 offset:4096
    ds_read_b128 v[84:87], v4 offset:5120
    v_exp_f32 v132, v132
    v_exp_f32 v133, v133
    v_exp_f32 v134, v134
    v_exp_f32 v135, v135
    v_cvt_pk_bf16_f32 v146, v132, v133
    v_cvt_pk_bf16_f32 v147, v134, v135
    v_mfma_f32_32x32x16_bf16 v[48:63], v[204:207], v[148:151], v[48:63]
    ds_read_b128 v[88:91], v4 offset:6144
    ds_read_b128 v[92:95], v4 offset:7168
    ds_read_b128 v[96:99], v4 offset:8192
    ds_read_b128 v[100:103], v4 offset:9216
    ds_read_b128 v[104:107], v4 offset:10240
    ds_read_b128 v[108:111], v4 offset:11264
    v_exp_f32 v136, v136
    v_exp_f32 v137, v137
    v_exp_f32 v138, v138
    v_exp_f32 v139, v139
    v_cvt_pk_bf16_f32 v148, v136, v137
    v_cvt_pk_bf16_f32 v149, v138, v139
    v_mfma_f32_32x32x16_bf16 v[48:63], v[216:219], v[144:147], v[48:63]
    v_exp_f32 v140, v140
    v_exp_f32 v141, v141
    v_exp_f32 v142, v142
    v_exp_f32 v143, v143
    v_cvt_pk_bf16_f32 v150, v140, v141
    v_cvt_pk_bf16_f32 v151, v142, v143
    s_waitcnt lgkmcnt(0)
    s_nop 0
    v_mfma_f32_32x32x16_bf16 v[48:63], v[220:223], v[148:151], v[48:63]
    v_pk_add_f32 v[64:65], v[64:65], v[80:81]
    v_pk_add_f32 v[66:67], v[66:67], v[82:83]
    v_pk_add_f32 v[68:69], v[68:69], v[84:85]
    v_pk_add_f32 v[70:71], v[70:71], v[86:87]
    v_pk_add_f32 v[72:73], v[72:73], v[88:89]
    v_pk_add_f32 v[74:75], v[74:75], v[90:91]
    v_pk_add_f32 v[76:77], v[76:77], v[92:93]
    v_pk_add_f32 v[78:79], v[78:79], v[94:95]
    v_pk_add_f32 v[64:65], v[64:65], v[96:97]
    v_pk_add_f32 v[66:67], v[66:67], v[98:99]
    v_pk_add_f32 v[68:69], v[68:69], v[100:101]
    v_pk_add_f32 v[70:71], v[70:71], v[102:103]
    v_pk_add_f32 v[72:73], v[72:73], v[104:105]
    v_pk_add_f32 v[74:75], v[74:75], v[106:107]
    v_pk_add_f32 v[76:77], v[76:77], v[108:109]
    v_pk_add_f32 v[78:79], v[78:79], v[110:111]
    v_pk_add_f32 v[54:55], v[54:55], v[70:71]
    v_pk_add_f32 v[48:49], v[48:49], v[64:65]
    v_rcp_f32 v6, v55
    v_cmp_ngt_f32 vcc, s38, v55
    v_pk_add_f32 v[50:51], v[50:51], v[66:67]
    v_pk_add_f32 v[52:53], v[52:53], v[68:69]
    v_pk_add_f32 v[56:57], v[56:57], v[72:73]
    v_pk_add_f32 v[58:59], v[58:59], v[74:75]
    v_pk_add_f32 v[60:61], v[60:61], v[76:77]
    v_pk_add_f32 v[62:63], v[62:63], v[78:79]
    s_cbranch_vccnz m_truemax
m_finish:
    v_mul_f32 v6, v6, v7
    v_pk_mul_f32 v[48:49], v[48:49], v[6:7] op_sel_hi:[1,0]
    v_pk_mul_f32 v[50:51], v[50:51], v[6:7] op_sel_hi:[1,0]
    v_pk_mul_f32 v[52:53], v[52:53], v[6:7] op_sel_hi:[1,0]
    v_pk_mul_f32 v[54:55], v[54:55], v[6:7] op_sel_hi:[1,0]
    v_cvt_pk_bf16_f32 v144, v48, v49
    v_cvt_pk_bf16_f32 v145, v50, v51
    v_cvt_pk_bf16_f32 v146, v52, v53
    v_cvt_pk_bf16_f32 v147, v54, v55
    v_or_b32 v147, s37, v147
    buffer_store_dwordx4 v[144:147], v1, s[16:19], s39 offen offset:0 sc1
    v_pk_mul_f32 v[56:57], v[56:57], v[6:7] op_sel_hi:[1,0]
    v_pk_mul_f32 v[58:59], v[58:59], v[6:7] op_sel_hi:[1,0]
    v_pk_mul_f32 v[60:61], v[60:61], v[6:7] op_sel_hi:[1,0]
    v_pk_mul_f32 v[62:63], v[62:63], v[6:7] op_sel_hi:[1,0]
    v_cvt_pk_bf16_f32 v148, v56, v57
    v_cvt_pk_bf16_f32 v149, v58, v59
    v_cvt_pk_bf16_f32 v150, v60, v61
    v_cvt_pk_bf16_f32 v151, v62, v63
    v_or_b32 v151, s37, v151
    buffer_store_dwordx4 v[148:151], v1, s[16:19], s39 offen offset:1024 sc1
    s_mov_b64 exec, 1
    ds_add_u32 v157, v158 offset:52
    s_waitcnt lgkmcnt(0)
    s_endpgm
m_truemax:
    s_mov_b32 s31, 0
    v_mov_b32 v8, 0xff800000
m_tm_loop:
    buffer_load_dwordx4 v[160:163], v152, s[16:19], s31 offen sc1
    buffer_load_dwordx4 v[164:167], v153, s[16:19], s31 offen sc1
    s_add_u32 s31, s31, 57344
    s_waitcnt vmcnt(0)
    v_cndmask_b32 v166, v166, v156, s[48:49]
    s_nop 1
    v_mfma_f32_32x32x16_bf16 v[112:127], v[160:163], v[16:19], 0
    v_mfma_f32_32x32x16_bf16 v[112:127], v[164:167], v[20:23], v[112:127]
    s_nop 15
    v_max3_f32 v8, v8, v112, v113
    v_max3_f32 v8, v8, v114, v115
    v_max3_f32 v8, v8, v116, v117
    v_max3_f32 v8, v8, v118, v119
    v_max3_f32 v8, v8, v120, v121
    v_max3_f32 v8, v8, v122, v123
    v_max3_f32 v8, v8, v124, v125
    v_max3_f32 v8, v8, v126, v127
    s_cmp_lt_u32 s31, 3670016
    s_cbranch_scc1 m_tm_loop
    v_mov_b32 v9, v8
    s_nop 1
    v_permlane32_swap_b32 v9, v8
    s_nop 1
    v_max_f32 v8, v8, v9
    s_mov_b32 s31, 0
    v_mov_b32 v48, 0
    v_mov_b32 v49, 0
    v_mov_b32 v50, 0
    v_mov_b32 v51, 0
    v_mov_b32 v52, 0
    v_mov_b32 v53, 0
    v_mov_b32 v54, 0
    v_mov_b32 v55, 0
    v_mov_b32 v56, 0
    v_mov_b32 v57, 0
    v_mov_b32 v58, 0
    v_mov_b32 v59, 0
    v_mov_b32 v60, 0
    v_mov_b32 v61, 0
    v_mov_b32 v62, 0
    v_mov_b32 v63, 0
m_tm_loop2:
    buffer_load_dwordx4 v[160:163], v152, s[16:19], s31 offen sc1
    buffer_load_dwordx4 v[164:167], v153, s[16:19], s31 offen sc1
    s_mov_b64 exec, s[50:51]
    buffer_load_dwordx4 v[168:171], v154, s[16:19], s31 offen sc1
    buffer_load_dwordx4 v[172:175], v155, s[16:19], s31 offen sc1
    s_mov_b64 exec, -1
    s_add_u32 s31, s31, 57344
    s_waitcnt vmcnt(0)
    v_cndmask_b32 v166, v166, v156, s[48:49]
    s_nop 1
    v_mfma_f32_32x32x16_bf16 v[112:127], v[160:163], v[16:19], 0
    v_mfma_f32_32x32x16_bf16 v[112:127], v[164:167], v[20:23], v[112:127]
    s_nop 15
    v_sub_f32 v112, v112, v8
    v_sub_f32 v113, v113, v8
    v_sub_f32 v114, v114, v8
    v_sub_f32 v115, v115, v8
    v_sub_f32 v116, v116, v8
    v_sub_f32 v117, v117, v8
    v_sub_f32 v118, v118, v8
    v_sub_f32 v119, v119, v8
    v_sub_f32 v120, v120, v8
    v_sub_f32 v121, v121, v8
    v_sub_f32 v122, v122, v8
    v_sub_f32 v123, v123, v8
    v_sub_f32 v124, v124, v8
    v_sub_f32 v125, v125, v8
    v_sub_f32 v126, v126, v8
    v_sub_f32 v127, v127, v8
    v_exp_f32 v112, v112
    v_exp_f32 v113, v113
    v_exp_f32 v114, v114
    v_exp_f32 v115, v115
    v_exp_f32 v116, v116
    v_exp_f32 v117, v117
    v_exp_f32 v118, v118
    v_exp_f32 v119, v119
    v_exp_f32 v120, v120
    v_exp_f32 v121, v121
    v_exp_f32 v122, v122
    v_exp_f32 v123, v123
    v_exp_f32 v124, v124
    v_exp_f32 v125, v125
    v_exp_f32 v126, v126
    v_exp_f32 v127, v127
    s_nop 0
    v_cvt_pk_bf16_f32 v144, v112, v113
    v_cvt_pk_bf16_f32 v145, v114, v115
    v_cvt_pk_bf16_f32 v146, v116, v117
    v_cvt_pk_bf16_f32 v147, v118, v119
    v_cvt_pk_bf16_f32 v148, v120, v121
    v_cvt_pk_bf16_f32 v149, v122, v123
    v_cvt_pk_bf16_f32 v150, v124, v125
    v_cvt_pk_bf16_f32 v151, v126, v127
    s_nop 1
    v_mfma_f32_32x32x16_bf16 v[48:63], v[168:171], v[144:147], v[48:63]
    v_mfma_f32_32x32x16_bf16 v[48:63], v[172:175], v[148:151], v[48:63]
    s_cmp_lt_u32 s31, 3670016
    s_cbranch_scc1 m_tm_loop2
    s_nop 15
    v_rcp_f32 v6, v55
    s_branch m_finish
all_end:
    s_endpgm
.section .rodata,"a"
.p2align 6
.amdhsa_kernel gated_mix__ssm_conv_h3__mha_block__prompt_kernel
  .amdhsa_next_free_vgpr 256
  .amdhsa_next_free_sgpr 102
  .amdhsa_accum_offset 256
  .amdhsa_group_segment_fixed_size 0
  .amdhsa_kernarg_size 104
  .amdhsa_user_sgpr_count 2
  .amdhsa_user_sgpr_kernarg_segment_ptr 1
  .amdhsa_system_sgpr_workgroup_id_x 1
.end_amdhsa_kernel
```
